```python
import torch

def _softmax(x, axis=-1):
    return torch.softmax(x, dim=axis)
def _gelu(x):
    return torch.nn.functional.gelu(x, approximate="tanh")
def _silu(x):
    return torch.nn.functional.silu(x)
def _sigmoid(x):
    return torch.sigmoid(x)
def _layernorm(x, axis=-1, eps=1e-5):
    m = x.mean(dim=axis, keepdim=True)
    v = x.var(dim=axis, keepdim=True, unbiased=False)
    return (x - m) / torch.sqrt(v + eps)
def _scatter_add(tgt, idx, src, axis=0):
    return tgt.clone().index_add_(axis, idx, src)
def _segment_sum(src, seg, n):
    out = torch.zeros((n,) + src.shape[1:], dtype=src.dtype)
    return out.index_add_(0, seg, src)
def _pad(x, pw):
    flat = tuple(v for pair in reversed(pw) for v in pair)
    return torch.nn.functional.pad(x, flat)

kernel_name = 'gated_mix__gqa_block_cached__glu_gated_glu__decode'

def setup_inputs():

    _w = (lambda a: (lambda t: t.to(torch.bfloat16) if t.is_floating_point() else t)(torch.as_tensor(a)))
    def _A_setup():
        B, Sq, D = 8, 1, 512
        Hq, Hkv, Sk, Dh = 32, 8, 8192, 128
        assert Hq % Hkv == 0, (Hq, Hkv)
        return {
            "x": _w((lambda *s: torch.randn(*s, dtype=torch.bfloat16) * 0.05)(B, Sq, D)),
            "k_cache": _w((lambda *s: torch.randn(*s, dtype=torch.bfloat16) * 6.4)(B, Hkv, Sk, Dh)),
            "v_cache": _w((lambda *s: torch.randn(*s, dtype=torch.bfloat16) * 0.4)(B, Hkv, Sk, Dh)),
            "wq": _w((lambda *s: torch.randn(*s, dtype=torch.bfloat16) * 6.4)(D, Hq * Dh) * (D ** -0.5)),
            "wo": _w((lambda *s: torch.randn(*s, dtype=torch.bfloat16) * 0.4)(Hq * Dh, D) * ((Hq * Dh) ** -0.5)),
        }
    _A_in = _A_setup()

    def _B_setup():
        B, S, D, F = 8, 1, 512, 1792
        return {
            "x": _w((lambda *s: torch.randn(*s, dtype=torch.bfloat16) * 0.05)(B, S, D)),
            "w_gate": _w((lambda *s: torch.randn(*s, dtype=torch.bfloat16) * 0.4)(D, F)),
            "w_up": _w((lambda *s: torch.randn(*s, dtype=torch.bfloat16) * 0.05)(D, F)),
            "w_down": _w((lambda *s: torch.randn(*s, dtype=torch.bfloat16) * 0.05)(F, D)),
        }
    _B_in = _B_setup()

    return {
        "A_x": _A_in["x"],
        "A_k_cache": _A_in["k_cache"],
        "A_v_cache": _A_in["v_cache"],
        "A_wq": _A_in["wq"],
        "A_wo": _A_in["wo"],
        "B_x": _B_in["x"],
        "B_w_gate": _B_in["w_gate"],
        "B_w_up": _B_in["w_up"],
        "B_w_down": _B_in["w_down"],
        "gate_w": _w((lambda *s: torch.randn(*s, dtype=torch.bfloat16) * 0.05)(512) * 16.0),
    }

def reference(A_x, A_k_cache, A_v_cache, A_wq, A_wo, B_x, B_w_gate, B_w_up, B_w_down, gate_w):
    def _A_ref(x, k_cache, v_cache, wq, wo):
        B, Sq, D = x.shape
        Hq, Dh = 32, 128
        Hkv = k_cache.shape[1]
        rep = Hq // Hkv
        q = (lambda x, *d: x.permute(*d))((x @ wq).reshape(B, Sq, Hq, Dh), 0, 2, 1, 3)
        k = (lambda x, n, axis: torch.repeat_interleave(x, n, dim=axis))(k_cache, rep, axis=1)
        v = (lambda x, n, axis: torch.repeat_interleave(x, n, dim=axis))(v_cache, rep, axis=1)
        scores = torch.einsum("bhqd,bhkd->bhqk", q, k) * (Dh ** -0.5)
        p = _softmax(scores, axis=-1)
        o = torch.einsum("bhqk,bhkd->bhqd", p, v)
        return (lambda x, *d: x.permute(*d))(o, 0, 2, 1, 3).reshape(B, Sq, Hq * Dh) @ wo

    def _B_ref(x, w_gate, w_up, w_down):
        g = torch.einsum("bsd,df->bsf", x, w_gate)
        u = torch.einsum("bsd,df->bsf", x, w_up)
        h = _sigmoid(g) * u
        return torch.einsum("bsf,fd->bsd", h, w_down)

    x = A_x
    g = _sigmoid((x * gate_w).sum(-1, keepdims=True))
    a = _A_ref(x, A_k_cache, A_v_cache, A_wq, A_wo)
    b = _B_ref(x, B_w_gate, B_w_up, B_w_down)
    return g * a + (1 - g) * b
```

```asm
; @launch grid=(256,1,1) block=(512,1,1) lds=84224
.amdgcn_target "amdgcn-amd-amdhsa--gfx950"
.text
.globl gated_mix__gqa_block_cached__glu_gated_glu__decode_kernel
.p2align 8
.type gated_mix__gqa_block_cached__glu_gated_glu__decode_kernel,@function
gated_mix__gqa_block_cached__glu_gated_glu__decode_kernel:
  s_cmp_ge_u32 s2, 256
  s_cbranch_scc1 L_end
  s_load_dwordx16 s[40:55], s[0:1], 0
  s_load_dwordx8 s[56:63], s[0:1], 64
  s_load_dwordx2 s[64:65], s[0:1], 96
  v_lshrrev_b32 v7, 6, v0
  v_and_b32 v1, 63, v0
  v_readfirstlane_b32 s3, v7
  v_mov_b32 v8, 82944
  v_mov_b32 v220, 0
  v_mov_b32 v221, 0
  v_mov_b32 v222, 0
  v_mov_b32 v223, 0
  ds_write_b128 v8, v[220:223]
  s_getpc_b64 s[82:83]
L_pc:
  v_lshlrev_b32 v8, 4, v0
  global_load_dwordx4 v[224:227], v8, s[82:83]
  v_add_u32 v9, 8192, v8
  s_mov_b32 s77, L_code_end-L_pc-16
  v_cmp_gt_u32 vcc, s77, v9
  s_and_saveexec_b64 s[86:87], vcc
  s_cbranch_execz L_pf_skip
  global_load_dwordx4 v[228:231], v9, s[82:83]
L_pf_skip:
  s_mov_b64 exec, -1
  v_lshlrev_b32 v3, 4, v1
  v_bfe_u32 v7, v1, 2, 2
  v_lshlrev_b32 v2, 8, v7
  v_lshrrev_b32 v8, 4, v1
  v_lshl_add_u32 v2, v8, 6, v2
  v_and_b32 v9, 3, v1
  v_lshl_add_u32 v2, v9, 4, v2
  v_lshlrev_b32 v10, 5, v7
  v_lshl_add_u32 v10, v8, 3, v10
  v_lshlrev_b32 v241, 1, v10
  v_lshl_add_u32 v239, v9, 10, v241
  v_lshlrev_b32 v240, 4, v9
  s_and_b32 s84, s2, 7
  s_lshr_b32 s71, s2, 3
  s_lshr_b32 s68, s2, 5
  s_lshr_b32 s70, s84, 1
  s_xor_b32 s79, s84, s70
  s_and_b32 s79, s79, 1
  s_and_b32 s69, s71, 3
  s_lshl_b32 s69, s69, 1
  s_add_u32 s69, s69, s79
  s_lshl_b32 s72, s68, 3
  s_add_u32 s72, s72, s69
  s_lshl_b32 s72, s72, 2
  s_add_u32 s72, s72, s70
  s_lshl_b32 s72, s72, 19
  s_lshl_b32 s79, s3, 12
  s_add_u32 s72, s72, s79
  s_mul_i32 s79, s84, 14
  s_add_u32 s79, s79, s71
  s_sub_u32 s79, s79, 16
  s_lshl_b32 s77, s84, 4
  s_add_u32 s77, s77, s71
  v_mov_b32 v238, 82952
  v_add_u32 v242, 83200, v3
  s_waitcnt lgkmcnt(0)
  s_mov_b32 s4, s42
  s_mov_b32 s5, s43
  s_mov_b32 s6, 134217728
  s_mov_b32 s7, 0x20000
  s_mov_b32 s8, s44
  s_mov_b32 s9, s45
  s_mov_b32 s10, 134217728
  s_mov_b32 s11, 0x20000
  s_mov_b32 s12, s64
  s_mov_b32 s13, s65
  s_mov_b32 s14, 536870912
  s_mov_b32 s15, 0x20000
  s_load_dwordx2 s[66:67], s[64:65], 0
  s_barrier
  s_cmp_lt_u32 s3, 4
  s_cbranch_scc1 L_unit
  s_mov_b32 s24, s48
  s_mov_b32 s25, s49
  s_mov_b32 s26, 4194304
  s_mov_b32 s27, 0x20000
  s_mov_b32 s28, s56
  s_mov_b32 s29, s57
  s_mov_b32 s30, 1835008
  s_mov_b32 s31, 0x20000
  s_cmp_gt_u32 s3, 5
  s_cbranch_scc1 L_nowd
  v_lshrrev_b32 v8, 4, v1
  v_bfe_u32 v7, v1, 3, 1
  v_and_b32 v9, 7, v1
  v_lshlrev_b32 v10, 14, v7
  v_lshl_add_u32 v10, v8, 12, v10
  v_lshl_add_u32 v243, v9, 4, v10
  s_and_b32 s80, s3, 1
  s_mul_i32 s79, s71, 57344
  s_lshl_b32 s77, s80, 15
  s_add_u32 s79, s79, s77
  s_lshl_b32 s77, s84, 7
  s_add_u32 s79, s79, s77
  s_lshl_b32 s80, s80, 12
  s_add_u32 s78, s80, 16384
  s_mov_b32 m0, s78
  s_nop 0
  buffer_load_dwordx4 v243, s[28:31], s79 offen offset:0 nt lds
  buffer_load_dwordx4 v243, s[28:31], s79 offen offset:1024 nt lds
  buffer_load_dwordx4 v243, s[28:31], s79 offen offset:2048 nt lds
  buffer_load_dwordx4 v243, s[28:31], s79 offen offset:3072 nt lds
L_nowd:
  s_add_u32 s77, s72, 0
  buffer_load_dwordx4 v[92:95], v2, s[4:7], s77 offen offset:0 nt
  buffer_load_dwordx4 v[96:99], v2, s[4:7], s77 offen offset:1024 nt
  s_add_u32 s77, s72, 0
  buffer_load_dwordx4 v[100:103], v2, s[4:7], s77 offen offset:2048 nt
  buffer_load_dwordx4 v[104:107], v2, s[4:7], s77 offen offset:3072 nt
  s_mov_b32 s20, s40
  s_mov_b32 s21, s41
  s_mov_b32 s22, 8192
  s_mov_b32 s23, 0x20000
  s_mov_b32 s36, s58
  s_mov_b32 s37, s59
  s_mov_b32 s38, 1024
  s_mov_b32 s39, 0x20000
  s_mov_b32 s24, s48
  s_mov_b32 s25, s49
  s_mov_b32 s26, 4194304
  s_mov_b32 s27, 0x20000
  s_mov_b32 s28, s56
  s_mov_b32 s29, s57
  s_mov_b32 s30, 1835008
  s_mov_b32 s31, 0x20000
  s_mov_b32 s32, s60
  s_mov_b32 s33, s61
  s_mov_b32 s34, 8192
  s_mov_b32 s35, 0x20000
  v_bfe_u32 v7, v1, 2, 2
  v_lshrrev_b32 v8, 4, v1
  v_and_b32 v9, 3, v1
  v_cmp_eq_u32 s[86:87], 0, v9
  v_cmp_eq_u32 s[88:89], v7, v8
  v_bfe_u32 v10, v1, 3, 1
  v_lshrrev_b32 v243, 5, v1
  v_cmp_eq_u32 s[90:91], v10, v243
  v_lshlrev_b32 v11, 9, v7
  v_lshl_add_u32 v11, v8, 7, v11
  v_lshl_add_u32 v11, v9, 5, v11
  s_mov_b32 s94, 0x05040100
  s_mov_b32 s95, 0x07060302
  v_mov_b32 v4, 0x3e0293ee
  v_mov_b32 v5, 0xf149f2ca
  v_mov_b32 v6, 0
  s_mov_b32 s58, 8
  s_mov_b32 s59, -1
  s_bitcmp1_b32 s84, 0
  s_cbranch_scc1 L_odd_0
  s_cmp_lt_u32 s3, 4
  s_cselect_b32 s58, 9, 8
  s_branch L_nt_0
L_odd_0:
  s_cmp_ge_u32 s3, 4
  s_cselect_b32 s58, 7, 8
L_nt_0:
  s_xor_b32 s61, s72, 0x80000
  s_add_u32 s61, s61, 475136
  s_waitcnt lgkmcnt(0)
  s_mul_i32 s66, s66, 0x0019660d
  s_add_u32 s66, s66, 0x3c6ef35f
  s_mul_i32 s67, s67, 0x41c64e6d
  s_add_u32 s67, s67, 0x3039
  v_mov_b32 v28, 0
  v_mov_b32 v29, 0
  v_mov_b32 v30, 0
  v_mov_b32 v31, 0
  v_mov_b32 v32, 0
  v_mov_b32 v33, 0
  v_mov_b32 v34, 0
  v_mov_b32 v35, 0
  v_mov_b32 v36, 0
  v_mov_b32 v37, 0
  v_mov_b32 v38, 0
  v_mov_b32 v39, 0
  v_mov_b32 v40, 0
  v_mov_b32 v41, 0
  v_mov_b32 v42, 0
  v_mov_b32 v43, 0
  v_mov_b32 v44, 0
  v_mov_b32 v45, 0
  v_mov_b32 v46, 0
  v_mov_b32 v47, 0
  v_mov_b32 v48, 0
  v_mov_b32 v49, 0
  v_mov_b32 v50, 0
  v_mov_b32 v51, 0
  v_mov_b32 v52, 0
  v_mov_b32 v53, 0
  v_mov_b32 v54, 0
  v_mov_b32 v55, 0
  v_mov_b32 v56, 0
  v_mov_b32 v57, 0
  v_mov_b32 v58, 0
  v_mov_b32 v59, 0
  s_branch L_paced
L_unit:
  s_cmp_lt_u32 s71, 16
  s_cbranch_scc0 L_unit_gu
  s_mov_b32 s73, 8192
  s_lshl_b32 s74, s77, 6
  s_lshl_b32 s75, s77, 7
  s_add_u32 s75, s75, 65536
  s_mov_b32 s16, s46
  s_mov_b32 s17, s47
  s_mov_b32 s18, 4194304
  s_mov_b32 s19, 0x20000
  s_branch L_unit_sel
L_unit_gu:
  s_mov_b32 s73, 3584
  s_cmp_ge_u32 s79, 56
  s_cselect_b32 s80, 56, 0
  s_cselect_b32 s75, 7168, 0
  s_cselect_b32 s16, s54, s52
  s_cselect_b32 s17, s55, s53
  s_cmp_lt_u32 s71, 30
  s_cselect_b32 s18, 1835008, 0
  s_mov_b32 s19, 0x20000
  s_add_u32 s75, s75, 262144
  s_sub_u32 s79, s79, s80
  s_lshl_b32 s74, s79, 6
  s_lshl_b32 s79, s79, 7
  s_add_u32 s75, s75, s79
L_unit_sel:
  v_mad_u32_u24 v243, v10, s73, v240
  s_lshl_b32 s77, s3, 7
  s_mul_i32 s77, s77, s73
  s_add_u32 s77, s77, s74
  buffer_load_dwordx4 v[60:63], v243, s[16:19], s77 offen nt
  s_add_u32 s77, s77, s73
  buffer_load_dwordx4 v[64:67], v243, s[16:19], s77 offen nt
  s_add_u32 s77, s77, s73
  buffer_load_dwordx4 v[68:71], v243, s[16:19], s77 offen nt
  s_add_u32 s77, s77, s73
  buffer_load_dwordx4 v[72:75], v243, s[16:19], s77 offen nt
  s_add_u32 s77, s77, s73
  buffer_load_dwordx4 v[76:79], v243, s[16:19], s77 offen nt
  s_add_u32 s77, s77, s73
  buffer_load_dwordx4 v[80:83], v243, s[16:19], s77 offen nt
  s_add_u32 s77, s77, s73
  buffer_load_dwordx4 v[84:87], v243, s[16:19], s77 offen nt
  s_add_u32 s77, s77, s73
  buffer_load_dwordx4 v[88:91], v243, s[16:19], s77 offen nt
  s_mov_b32 s20, s40
  s_mov_b32 s21, s41
  s_mov_b32 s22, 8192
  s_mov_b32 s23, 0x20000
  s_mov_b32 s36, s58
  s_mov_b32 s37, s59
  s_mov_b32 s38, 1024
  s_mov_b32 s39, 0x20000
  s_lshl_b32 s77, s3, 8
  buffer_load_dwordx4 v[20:23], v239, s[20:23], s77 offen
  buffer_load_dwordx4 v[16:19], v241, s[36:39], s77 offen
  s_add_u32 s77, s77, 4096
  buffer_load_dwordx4 v[24:27], v239, s[20:23], s77 offen
  s_add_u32 s77, s72, 0
  buffer_load_dwordx4 v[92:95], v2, s[4:7], s77 offen offset:0 nt
  buffer_load_dwordx4 v[96:99], v2, s[4:7], s77 offen offset:1024 nt
  s_add_u32 s77, s72, 0
  buffer_load_dwordx4 v[100:103], v2, s[4:7], s77 offen offset:2048 nt
  buffer_load_dwordx4 v[104:107], v2, s[4:7], s77 offen offset:3072 nt
  s_mov_b32 s20, s40
  s_mov_b32 s21, s41
  s_mov_b32 s22, 8192
  s_mov_b32 s23, 0x20000
  s_mov_b32 s36, s58
  s_mov_b32 s37, s59
  s_mov_b32 s38, 1024
  s_mov_b32 s39, 0x20000
  s_mov_b32 s24, s48
  s_mov_b32 s25, s49
  s_mov_b32 s26, 4194304
  s_mov_b32 s27, 0x20000
  s_mov_b32 s28, s56
  s_mov_b32 s29, s57
  s_mov_b32 s30, 1835008
  s_mov_b32 s31, 0x20000
  s_mov_b32 s32, s60
  s_mov_b32 s33, s61
  s_mov_b32 s34, 8192
  s_mov_b32 s35, 0x20000
  v_bfe_u32 v7, v1, 2, 2
  v_lshrrev_b32 v8, 4, v1
  v_and_b32 v9, 3, v1
  v_cmp_eq_u32 s[86:87], 0, v9
  v_cmp_eq_u32 s[88:89], v7, v8
  v_bfe_u32 v10, v1, 3, 1
  v_lshrrev_b32 v243, 5, v1
  v_cmp_eq_u32 s[90:91], v10, v243
  v_lshlrev_b32 v11, 9, v7
  v_lshl_add_u32 v11, v8, 7, v11
  v_lshl_add_u32 v11, v9, 5, v11
  s_mov_b32 s94, 0x05040100
  s_mov_b32 s95, 0x07060302
  v_mov_b32 v4, 0x3e0293ee
  v_mov_b32 v5, 0xf149f2ca
  v_mov_b32 v6, 0
  s_mov_b32 s58, 8
  s_mov_b32 s59, -1
  s_bitcmp1_b32 s84, 0
  s_cbranch_scc1 L_odd_1
  s_cmp_lt_u32 s3, 4
  s_cselect_b32 s58, 9, 8
  s_branch L_nt_1
L_odd_1:
  s_cmp_ge_u32 s3, 4
  s_cselect_b32 s58, 7, 8
L_nt_1:
  s_xor_b32 s61, s72, 0x80000
  s_add_u32 s61, s61, 475136
  s_waitcnt lgkmcnt(0)
  s_mul_i32 s66, s66, 0x0019660d
  s_add_u32 s66, s66, 0x3c6ef35f
  s_mul_i32 s67, s67, 0x41c64e6d
  s_add_u32 s67, s67, 0x3039
  v_lshrrev_b32 v8, 4, v1
  v_and_b32 v9, 3, v1
  s_lshl_b32 s77, s3, 2
  v_add_u32 v8, s77, v8
  v_lshlrev_b32 v239, 10, v8
  v_lshl_add_u32 v239, v9, 7, v239
  v_lshlrev_b32 v240, 5, v8
  v_lshl_add_u32 v240, v9, 2, v240
  v_add_u32 v240, 82176, v240
  s_waitcnt vmcnt(4)
  v_mfma_f32_16x16x32_bf16 v[220:223], v[16:19], v[20:23], 0
  v_mfma_f32_16x16x32_bf16 v[224:227], v[16:19], v[24:27], 0
  v_perm_b32 v28, v64, v60, s94
  v_perm_b32 v29, v72, v68, s94
  v_perm_b32 v30, v80, v76, s94
  v_perm_b32 v31, v88, v84, s94
  v_perm_b32 v32, v64, v60, s95
  v_perm_b32 v33, v72, v68, s95
  v_perm_b32 v34, v80, v76, s95
  v_perm_b32 v35, v88, v84, s95
  v_perm_b32 v36, v65, v61, s94
  v_perm_b32 v37, v73, v69, s94
  v_perm_b32 v38, v81, v77, s94
  v_perm_b32 v39, v89, v85, s94
  v_perm_b32 v40, v65, v61, s95
  v_perm_b32 v41, v73, v69, s95
  v_perm_b32 v42, v81, v77, s95
  v_perm_b32 v43, v89, v85, s95
  v_perm_b32 v44, v66, v62, s94
  v_perm_b32 v45, v74, v70, s94
  v_perm_b32 v46, v82, v78, s94
  v_perm_b32 v47, v90, v86, s94
  v_perm_b32 v48, v66, v62, s95
  v_perm_b32 v49, v74, v70, s95
  v_perm_b32 v50, v82, v78, s95
  v_perm_b32 v51, v90, v86, s95
  v_perm_b32 v52, v67, v63, s94
  v_perm_b32 v53, v75, v71, s94
  v_perm_b32 v54, v83, v79, s94
  v_perm_b32 v55, v91, v87, s94
  v_perm_b32 v56, v67, v63, s95
  v_perm_b32 v57, v75, v71, s95
  v_perm_b32 v58, v83, v79, s95
  v_perm_b32 v59, v91, v87, s95
  s_nop 0
  v_mfma_f32_16x16x32_bf16 v[124:127], v[28:31], v[20:23], 0
  v_mfma_f32_16x16x32_bf16 v[188:191], v[28:31], v[24:27], 0
  v_mfma_f32_16x16x32_bf16 v[128:131], v[32:35], v[20:23], 0
  v_mfma_f32_16x16x32_bf16 v[192:195], v[32:35], v[24:27], 0
  v_mfma_f32_16x16x32_bf16 v[132:135], v[36:39], v[20:23], 0
  v_mfma_f32_16x16x32_bf16 v[196:199], v[36:39], v[24:27], 0
  v_mfma_f32_16x16x32_bf16 v[136:139], v[40:43], v[20:23], 0
  v_mfma_f32_16x16x32_bf16 v[200:203], v[40:43], v[24:27], 0
  v_mfma_f32_16x16x32_bf16 v[140:143], v[44:47], v[20:23], 0
  v_mfma_f32_16x16x32_bf16 v[204:207], v[44:47], v[24:27], 0
  v_mfma_f32_16x16x32_bf16 v[144:147], v[48:51], v[20:23], 0
  v_mfma_f32_16x16x32_bf16 v[208:211], v[48:51], v[24:27], 0
  v_mfma_f32_16x16x32_bf16 v[148:151], v[52:55], v[20:23], 0
  v_mfma_f32_16x16x32_bf16 v[212:215], v[52:55], v[24:27], 0
  v_mfma_f32_16x16x32_bf16 v[152:155], v[56:59], v[20:23], 0
  v_mfma_f32_16x16x32_bf16 v[216:219], v[56:59], v[24:27], 0
  s_mov_b64 exec, s[88:89]
  ds_write_b32 v240, v220
  ds_write_b32 v240, v224 offset:16
  s_nop 4
  ds_write_b128 v239, v[124:127] offset:0
  ds_write_b128 v239, v[128:131] offset:16
  ds_write_b128 v239, v[132:135] offset:32
  ds_write_b128 v239, v[136:139] offset:48
  ds_write_b128 v239, v[140:143] offset:64
  ds_write_b128 v239, v[144:147] offset:80
  ds_write_b128 v239, v[148:151] offset:96
  ds_write_b128 v239, v[152:155] offset:112
  ds_write_b128 v239, v[188:191] offset:512
  ds_write_b128 v239, v[192:195] offset:528
  ds_write_b128 v239, v[196:199] offset:544
  ds_write_b128 v239, v[200:203] offset:560
  ds_write_b128 v239, v[204:207] offset:576
  ds_write_b128 v239, v[208:211] offset:592
  ds_write_b128 v239, v[212:215] offset:608
  ds_write_b128 v239, v[216:219] offset:624
  s_mov_b64 exec, -1
  v_mov_b32 v7, 82944
  v_mov_b32 v8, 1
  s_waitcnt lgkmcnt(0)
  s_mov_b64 exec, 1
  ds_add_u32 v7, v8
  s_mov_b64 exec, -1
  v_mov_b32 v28, 0
  v_mov_b32 v29, 0
  v_mov_b32 v30, 0
  v_mov_b32 v31, 0
  v_mov_b32 v32, 0
  v_mov_b32 v33, 0
  v_mov_b32 v34, 0
  v_mov_b32 v35, 0
  v_mov_b32 v36, 0
  v_mov_b32 v37, 0
  v_mov_b32 v38, 0
  v_mov_b32 v39, 0
  v_mov_b32 v40, 0
  v_mov_b32 v41, 0
  v_mov_b32 v42, 0
  v_mov_b32 v43, 0
  v_mov_b32 v44, 0
  v_mov_b32 v45, 0
  v_mov_b32 v46, 0
  v_mov_b32 v47, 0
  v_mov_b32 v48, 0
  v_mov_b32 v49, 0
  v_mov_b32 v50, 0
  v_mov_b32 v51, 0
  v_mov_b32 v52, 0
  v_mov_b32 v53, 0
  v_mov_b32 v54, 0
  v_mov_b32 v55, 0
  v_mov_b32 v56, 0
  v_mov_b32 v57, 0
  v_mov_b32 v58, 0
  v_mov_b32 v59, 0
  v_lshrrev_b32 v240, 5, v0
  v_and_b32 v8, 7, v0
  v_bfe_u32 v241, v0, 3, 2
  v_lshlrev_b32 v10, 7, v240
  v_lshl_add_u32 v10, v8, 4, v10
  v_lshl_add_u32 v10, v241, 2, v10
  v_and_b32 v8, 31, v0
  v_lshlrev_b32 v240, 14, v240
  v_lshl_add_u32 v239, v8, 2, v240
  v_mov_b32 v189, s66
  v_mov_b32 v191, s67
  v_mov_b32 v9, 82944
  s_mov_b32 s96, 4000000
L_uw:
  ds_read_b32 v7, v9
  s_waitcnt lgkmcnt(0)
  v_cmp_ne_u32 vcc, 4, v7
  s_cbranch_vccz L_uw_ok
  s_sub_u32 s96, s96, 1
  s_cmp_lg_u32 s96, 0
  s_cbranch_scc1 L_uw
L_uw_ok:
  ds_read_b32 v124, v10 offset:0
  ds_read_b32 v125, v10 offset:1024
  ds_read_b32 v126, v10 offset:2048
  ds_read_b32 v127, v10 offset:3072
  ds_read_b32 v128, v10 offset:4096
  ds_read_b32 v129, v10 offset:5120
  ds_read_b32 v130, v10 offset:6144
  ds_read_b32 v131, v10 offset:7168
  ds_read_b32 v132, v10 offset:8192
  ds_read_b32 v133, v10 offset:9216
  ds_read_b32 v134, v10 offset:10240
  ds_read_b32 v135, v10 offset:11264
  ds_read_b32 v136, v10 offset:12288
  ds_read_b32 v137, v10 offset:13312
  ds_read_b32 v138, v10 offset:14336
  ds_read_b32 v139, v10 offset:15360
  s_waitcnt lgkmcnt(0)
  v_add_f32 v124, v124, v132
  v_add_f32 v125, v125, v133
  v_add_f32 v126, v126, v134
  v_add_f32 v127, v127, v135
  v_add_f32 v128, v128, v136
  v_add_f32 v129, v129, v137
  v_add_f32 v130, v130, v138
  v_add_f32 v131, v131, v139
  v_add_f32 v124, v124, v128
  v_add_f32 v125, v125, v129
  v_add_f32 v126, v126, v130
  v_add_f32 v127, v127, v131
  v_add_f32 v124, v124, v126
  v_add_f32 v125, v125, v127
  v_add_f32 v124, v124, v125
  s_nop 1
  v_mov_b32_dpp v125, v124 quad_perm:[1,1,1,1] row_mask:0xf bank_mask:0xf
  v_mov_b32_dpp v126, v124 quad_perm:[2,2,2,2] row_mask:0xf bank_mask:0xf
  v_mov_b32_dpp v127, v124 quad_perm:[3,3,3,3] row_mask:0xf bank_mask:0xf
  v_cvt_pk_bf16_f32 v188, v124, v125
  v_cvt_pk_bf16_f32 v190, v126, v127
  s_cmp_ge_u32 s71, 30
  s_cbranch_scc1 L_nopub_u
  s_mov_b64 exec, s[86:87]
  buffer_store_dwordx4 v[188:191], v239, s[12:15], s75 offen sc1
  s_mov_b64 exec, -1
  s_nop 1
L_nopub_u:
  s_cmp_eq_u32 s3, 0
  s_cbranch_scc1 L_poller
L_paced:
  s_add_u32 s77, s72, 32768
  buffer_load_dwordx4 v[108:111], v2, s[4:7], s77 offen offset:0 nt
  buffer_load_dwordx4 v[112:115], v2, s[4:7], s77 offen offset:1024 nt
  s_waitcnt vmcnt(4)
  ds_read_b32 v7, v238
  s_waitcnt lgkmcnt(0)
  v_cmp_ne_u32 vcc, 0, v7
  s_cbranch_vccnz L_rest_6
  s_add_u32 s77, s72, 32768
  buffer_load_dwordx4 v[116:119], v2, s[4:7], s77 offen offset:2048 nt
  buffer_load_dwordx4 v[120:123], v2, s[4:7], s77 offen offset:3072 nt
  s_waitcnt vmcnt(4)
  ds_read_b32 v7, v238
  s_waitcnt lgkmcnt(0)
  v_cmp_ne_u32 vcc, 0, v7
  s_cbranch_vccnz L_rest_8
  s_add_u32 s77, s72, 0
  buffer_load_dwordx4 v[156:159], v3, s[8:11], s77 offen offset:0 nt
  buffer_load_dwordx4 v[160:163], v3, s[8:11], s77 offen offset:1024 nt
  s_waitcnt vmcnt(4)
  ds_read_b32 v7, v238
  s_waitcnt lgkmcnt(0)
  v_cmp_ne_u32 vcc, 0, v7
  s_cbranch_vccnz L_rest_10
  s_add_u32 s77, s72, 0
  buffer_load_dwordx4 v[164:167], v3, s[8:11], s77 offen offset:2048 nt
  buffer_load_dwordx4 v[168:171], v3, s[8:11], s77 offen offset:3072 nt
  s_waitcnt vmcnt(4)
  ds_read_b32 v7, v238
  s_waitcnt lgkmcnt(0)
  v_cmp_ne_u32 vcc, 0, v7
  s_cbranch_vccnz L_rest_12
  s_add_u32 s77, s72, 32768
  buffer_load_dwordx4 v[172:175], v3, s[8:11], s77 offen offset:0 nt
  buffer_load_dwordx4 v[176:179], v3, s[8:11], s77 offen offset:1024 nt
  s_waitcnt vmcnt(4)
  ds_read_b32 v7, v238
  s_waitcnt lgkmcnt(0)
  v_cmp_ne_u32 vcc, 0, v7
  s_cbranch_vccnz L_rest_14
  s_add_u32 s77, s72, 32768
  buffer_load_dwordx4 v[180:183], v3, s[8:11], s77 offen offset:2048 nt
  buffer_load_dwordx4 v[184:187], v3, s[8:11], s77 offen offset:3072 nt
  s_waitcnt vmcnt(4)
  ds_read_b32 v7, v238
  s_waitcnt lgkmcnt(0)
  v_cmp_ne_u32 vcc, 0, v7
  s_cbranch_vccnz L_rest_16
  s_add_u32 s77, s72, 65536
  buffer_load_dwordx4 v[124:127], v2, s[4:7], s77 offen offset:0 nt
  buffer_load_dwordx4 v[128:131], v2, s[4:7], s77 offen offset:1024 nt
  s_waitcnt vmcnt(4)
  ds_read_b32 v7, v238
  s_waitcnt lgkmcnt(0)
  v_cmp_ne_u32 vcc, 0, v7
  s_cbranch_vccnz L_rest_18
  s_add_u32 s77, s72, 65536
  buffer_load_dwordx4 v[132:135], v2, s[4:7], s77 offen offset:2048 nt
  buffer_load_dwordx4 v[136:139], v2, s[4:7], s77 offen offset:3072 nt
  s_waitcnt vmcnt(4)
  ds_read_b32 v7, v238
  s_waitcnt lgkmcnt(0)
  v_cmp_ne_u32 vcc, 0, v7
  s_cbranch_vccnz L_rest_20
  s_add_u32 s77, s72, 98304
  buffer_load_dwordx4 v[140:143], v2, s[4:7], s77 offen offset:0 nt
  buffer_load_dwordx4 v[144:147], v2, s[4:7], s77 offen offset:1024 nt
  s_waitcnt vmcnt(4)
  ds_read_b32 v7, v238
  s_waitcnt lgkmcnt(0)
  v_cmp_ne_u32 vcc, 0, v7
  s_cbranch_vccnz L_rest_22
  s_add_u32 s77, s72, 98304
  buffer_load_dwordx4 v[148:151], v2, s[4:7], s77 offen offset:2048 nt
  buffer_load_dwordx4 v[152:155], v2, s[4:7], s77 offen offset:3072 nt
  s_waitcnt vmcnt(4)
  ds_read_b32 v7, v238
  s_waitcnt lgkmcnt(0)
  v_cmp_ne_u32 vcc, 0, v7
  s_cbranch_vccnz L_rest_24
  s_add_u32 s77, s72, 65536
  buffer_load_dwordx4 v[188:191], v3, s[8:11], s77 offen offset:0 nt
  buffer_load_dwordx4 v[192:195], v3, s[8:11], s77 offen offset:1024 nt
  s_waitcnt vmcnt(4)
  ds_read_b32 v7, v238
  s_waitcnt lgkmcnt(0)
  v_cmp_ne_u32 vcc, 0, v7
  s_cbranch_vccnz L_rest_26
  s_add_u32 s77, s72, 65536
  buffer_load_dwordx4 v[196:199], v3, s[8:11], s77 offen offset:2048 nt
  buffer_load_dwordx4 v[200:203], v3, s[8:11], s77 offen offset:3072 nt
  s_waitcnt vmcnt(4)
  ds_read_b32 v7, v238
  s_waitcnt lgkmcnt(0)
  v_cmp_ne_u32 vcc, 0, v7
  s_cbranch_vccnz L_rest_28
  s_add_u32 s77, s72, 98304
  buffer_load_dwordx4 v[204:207], v3, s[8:11], s77 offen offset:0 nt
  buffer_load_dwordx4 v[208:211], v3, s[8:11], s77 offen offset:1024 nt
  s_waitcnt vmcnt(4)
  ds_read_b32 v7, v238
  s_waitcnt lgkmcnt(0)
  v_cmp_ne_u32 vcc, 0, v7
  s_cbranch_vccnz L_rest_30
  s_add_u32 s77, s72, 98304
  buffer_load_dwordx4 v[212:215], v3, s[8:11], s77 offen offset:2048 nt
  buffer_load_dwordx4 v[216:219], v3, s[8:11], s77 offen offset:3072 nt
  s_waitcnt vmcnt(4)
  ds_read_b32 v7, v238
  s_waitcnt lgkmcnt(0)
  v_cmp_ne_u32 vcc, 0, v7
  s_cbranch_vccnz L_rest_32
L_pf2:
  s_mov_b32 s96, 2000000
L_qspin:
  ds_read_b32 v7, v238
  s_waitcnt lgkmcnt(0)
  v_cmp_ne_u32 vcc, 0, v7
  s_cbranch_vccnz L_rest_32
  s_sleep 1
  s_sub_u32 s96, s96, 1
  s_cmp_lg_u32 s96, 0
  s_cbranch_scc1 L_qspin
  s_branch L_rest_32
L_poller:
  s_setprio 3
  s_lshl_b32 s80, s68, 14
  s_lshl_b32 s77, s69, 11
  s_add_u32 s80, s80, s77
  s_add_u32 s80, s80, 65536
  v_and_b32 v10, 7, v1
  v_lshlrev_b32 v10, 2, v10
  v_add_u32 v10, 82176, v10
  ds_read_b32 v60, v10 offset:0
  ds_read_b32 v61, v10 offset:32
  ds_read_b32 v62, v10 offset:64
  ds_read_b32 v63, v10 offset:96
  ds_read_b32 v64, v10 offset:128
  ds_read_b32 v65, v10 offset:160
  ds_read_b32 v66, v10 offset:192
  ds_read_b32 v67, v10 offset:224
  ds_read_b32 v68, v10 offset:256
  ds_read_b32 v69, v10 offset:288
  ds_read_b32 v70, v10 offset:320
  ds_read_b32 v71, v10 offset:352
  ds_read_b32 v72, v10 offset:384
  ds_read_b32 v73, v10 offset:416
  ds_read_b32 v74, v10 offset:448
  ds_read_b32 v75, v10 offset:480
  s_waitcnt lgkmcnt(0)
  v_add_f32 v60, v60, v68
  v_add_f32 v61, v61, v69
  v_add_f32 v62, v62, v70
  v_add_f32 v63, v63, v71
  v_add_f32 v64, v64, v72
  v_add_f32 v65, v65, v73
  v_add_f32 v66, v66, v74
  v_add_f32 v67, v67, v75
  v_add_f32 v60, v60, v64
  v_add_f32 v61, v61, v65
  v_add_f32 v62, v62, v66
  v_add_f32 v63, v63, v67
  v_add_f32 v60, v60, v62
  v_add_f32 v61, v61, v63
  v_add_f32 v60, v60, v61
  v_mul_f32 v61, 0xbfb8aa3b, v60
  v_exp_f32 v61, v61
  s_nop 0
  v_add_f32 v61, 1.0, v61
  v_rcp_f32 v61, v61
  s_mov_b32 s96, 200000
  v_sub_f32 v62, 1.0, v61
  ds_write_b32 v10, v61 offset:512
  ds_write_b32 v10, v62 offset:544
  s_add_u32 s77, s72, 32768
  buffer_load_dwordx4 v[108:111], v2, s[4:7], s77 offen offset:0 nt
  buffer_load_dwordx4 v[112:115], v2, s[4:7], s77 offen offset:1024 nt
  buffer_load_dwordx4 v[220:223], v11, s[12:15], s80 offen sc1
  buffer_load_dwordx4 v[224:227], v11, s[12:15], s80 offen offset:16 sc1
  s_waitcnt vmcnt(0)
  v_xor_b32 v8, s66, v221
  v_xor_b32 v9, s67, v223
  v_or_b32 v7, v8, v9
  v_xor_b32 v8, s66, v225
  v_xor_b32 v9, s67, v227
  v_or3_b32 v7, v7, v8, v9
  v_cmp_ne_u32 vcc, 0, v7
  s_cbranch_vccz L_pok_6
  s_add_u32 s77, s72, 32768
  buffer_load_dwordx4 v[116:119], v2, s[4:7], s77 offen offset:2048 nt
  buffer_load_dwordx4 v[120:123], v2, s[4:7], s77 offen offset:3072 nt
  buffer_load_dwordx4 v[220:223], v11, s[12:15], s80 offen sc1
  buffer_load_dwordx4 v[224:227], v11, s[12:15], s80 offen offset:16 sc1
  s_waitcnt vmcnt(0)
  v_xor_b32 v8, s66, v221
  v_xor_b32 v9, s67, v223
  v_or_b32 v7, v8, v9
  v_xor_b32 v8, s66, v225
  v_xor_b32 v9, s67, v227
  v_or3_b32 v7, v7, v8, v9
  v_cmp_ne_u32 vcc, 0, v7
  s_cbranch_vccz L_pok_8
  s_add_u32 s77, s72, 0
  buffer_load_dwordx4 v[156:159], v3, s[8:11], s77 offen offset:0 nt
  buffer_load_dwordx4 v[160:163], v3, s[8:11], s77 offen offset:1024 nt
  buffer_load_dwordx4 v[220:223], v11, s[12:15], s80 offen sc1
  buffer_load_dwordx4 v[224:227], v11, s[12:15], s80 offen offset:16 sc1
  s_waitcnt vmcnt(0)
  v_xor_b32 v8, s66, v221
  v_xor_b32 v9, s67, v223
  v_or_b32 v7, v8, v9
  v_xor_b32 v8, s66, v225
  v_xor_b32 v9, s67, v227
  v_or3_b32 v7, v7, v8, v9
  v_cmp_ne_u32 vcc, 0, v7
  s_cbranch_vccz L_pok_10
  s_add_u32 s77, s72, 0
  buffer_load_dwordx4 v[164:167], v3, s[8:11], s77 offen offset:2048 nt
  buffer_load_dwordx4 v[168:171], v3, s[8:11], s77 offen offset:3072 nt
  buffer_load_dwordx4 v[220:223], v11, s[12:15], s80 offen sc1
  buffer_load_dwordx4 v[224:227], v11, s[12:15], s80 offen offset:16 sc1
  s_waitcnt vmcnt(0)
  v_xor_b32 v8, s66, v221
  v_xor_b32 v9, s67, v223
  v_or_b32 v7, v8, v9
  v_xor_b32 v8, s66, v225
  v_xor_b32 v9, s67, v227
  v_or3_b32 v7, v7, v8, v9
  v_cmp_ne_u32 vcc, 0, v7
  s_cbranch_vccz L_pok_12
  s_add_u32 s77, s72, 32768
  buffer_load_dwordx4 v[172:175], v3, s[8:11], s77 offen offset:0 nt
  buffer_load_dwordx4 v[176:179], v3, s[8:11], s77 offen offset:1024 nt
  buffer_load_dwordx4 v[220:223], v11, s[12:15], s80 offen sc1
  buffer_load_dwordx4 v[224:227], v11, s[12:15], s80 offen offset:16 sc1
  s_waitcnt vmcnt(0)
  v_xor_b32 v8, s66, v221
  v_xor_b32 v9, s67, v223
  v_or_b32 v7, v8, v9
  v_xor_b32 v8, s66, v225
  v_xor_b32 v9, s67, v227
  v_or3_b32 v7, v7, v8, v9
  v_cmp_ne_u32 vcc, 0, v7
  s_cbranch_vccz L_pok_14
  s_add_u32 s77, s72, 32768
  buffer_load_dwordx4 v[180:183], v3, s[8:11], s77 offen offset:2048 nt
  buffer_load_dwordx4 v[184:187], v3, s[8:11], s77 offen offset:3072 nt
  buffer_load_dwordx4 v[220:223], v11, s[12:15], s80 offen sc1
  buffer_load_dwordx4 v[224:227], v11, s[12:15], s80 offen offset:16 sc1
  s_waitcnt vmcnt(0)
  v_xor_b32 v8, s66, v221
  v_xor_b32 v9, s67, v223
  v_or_b32 v7, v8, v9
  v_xor_b32 v8, s66, v225
  v_xor_b32 v9, s67, v227
  v_or3_b32 v7, v7, v8, v9
  v_cmp_ne_u32 vcc, 0, v7
  s_cbranch_vccz L_pok_16
  s_add_u32 s77, s72, 65536
  buffer_load_dwordx4 v[124:127], v2, s[4:7], s77 offen offset:0 nt
  buffer_load_dwordx4 v[128:131], v2, s[4:7], s77 offen offset:1024 nt
  buffer_load_dwordx4 v[220:223], v11, s[12:15], s80 offen sc1
  buffer_load_dwordx4 v[224:227], v11, s[12:15], s80 offen offset:16 sc1
  s_waitcnt vmcnt(0)
  v_xor_b32 v8, s66, v221
  v_xor_b32 v9, s67, v223
  v_or_b32 v7, v8, v9
  v_xor_b32 v8, s66, v225
  v_xor_b32 v9, s67, v227
  v_or3_b32 v7, v7, v8, v9
  v_cmp_ne_u32 vcc, 0, v7
  s_cbranch_vccz L_pok_18
  s_add_u32 s77, s72, 65536
  buffer_load_dwordx4 v[132:135], v2, s[4:7], s77 offen offset:2048 nt
  buffer_load_dwordx4 v[136:139], v2, s[4:7], s77 offen offset:3072 nt
  buffer_load_dwordx4 v[220:223], v11, s[12:15], s80 offen sc1
  buffer_load_dwordx4 v[224:227], v11, s[12:15], s80 offen offset:16 sc1
  s_waitcnt vmcnt(0)
  v_xor_b32 v8, s66, v221
  v_xor_b32 v9, s67, v223
  v_or_b32 v7, v8, v9
  v_xor_b32 v8, s66, v225
  v_xor_b32 v9, s67, v227
  v_or3_b32 v7, v7, v8, v9
  v_cmp_ne_u32 vcc, 0, v7
  s_cbranch_vccz L_pok_20
  s_add_u32 s77, s72, 98304
  buffer_load_dwordx4 v[140:143], v2, s[4:7], s77 offen offset:0 nt
  buffer_load_dwordx4 v[144:147], v2, s[4:7], s77 offen offset:1024 nt
  buffer_load_dwordx4 v[220:223], v11, s[12:15], s80 offen sc1
  buffer_load_dwordx4 v[224:227], v11, s[12:15], s80 offen offset:16 sc1
  s_waitcnt vmcnt(0)
  v_xor_b32 v8, s66, v221
  v_xor_b32 v9, s67, v223
  v_or_b32 v7, v8, v9
  v_xor_b32 v8, s66, v225
  v_xor_b32 v9, s67, v227
  v_or3_b32 v7, v7, v8, v9
  v_cmp_ne_u32 vcc, 0, v7
  s_cbranch_vccz L_pok_22
  s_add_u32 s77, s72, 98304
  buffer_load_dwordx4 v[148:151], v2, s[4:7], s77 offen offset:2048 nt
  buffer_load_dwordx4 v[152:155], v2, s[4:7], s77 offen offset:3072 nt
  buffer_load_dwordx4 v[220:223], v11, s[12:15], s80 offen sc1
  buffer_load_dwordx4 v[224:227], v11, s[12:15], s80 offen offset:16 sc1
  s_waitcnt vmcnt(0)
  v_xor_b32 v8, s66, v221
  v_xor_b32 v9, s67, v223
  v_or_b32 v7, v8, v9
  v_xor_b32 v8, s66, v225
  v_xor_b32 v9, s67, v227
  v_or3_b32 v7, v7, v8, v9
  v_cmp_ne_u32 vcc, 0, v7
  s_cbranch_vccz L_pok_24
  s_add_u32 s77, s72, 65536
  buffer_load_dwordx4 v[188:191], v3, s[8:11], s77 offen offset:0 nt
  buffer_load_dwordx4 v[192:195], v3, s[8:11], s77 offen offset:1024 nt
  buffer_load_dwordx4 v[220:223], v11, s[12:15], s80 offen sc1
  buffer_load_dwordx4 v[224:227], v11, s[12:15], s80 offen offset:16 sc1
  s_waitcnt vmcnt(0)
  v_xor_b32 v8, s66, v221
  v_xor_b32 v9, s67, v223
  v_or_b32 v7, v8, v9
  v_xor_b32 v8, s66, v225
  v_xor_b32 v9, s67, v227
  v_or3_b32 v7, v7, v8, v9
  v_cmp_ne_u32 vcc, 0, v7
  s_cbranch_vccz L_pok_26
  s_add_u32 s77, s72, 65536
  buffer_load_dwordx4 v[196:199], v3, s[8:11], s77 offen offset:2048 nt
  buffer_load_dwordx4 v[200:203], v3, s[8:11], s77 offen offset:3072 nt
  buffer_load_dwordx4 v[220:223], v11, s[12:15], s80 offen sc1
  buffer_load_dwordx4 v[224:227], v11, s[12:15], s80 offen offset:16 sc1
  s_waitcnt vmcnt(0)
  v_xor_b32 v8, s66, v221
  v_xor_b32 v9, s67, v223
  v_or_b32 v7, v8, v9
  v_xor_b32 v8, s66, v225
  v_xor_b32 v9, s67, v227
  v_or3_b32 v7, v7, v8, v9
  v_cmp_ne_u32 vcc, 0, v7
  s_cbranch_vccz L_pok_28
  s_add_u32 s77, s72, 98304
  buffer_load_dwordx4 v[204:207], v3, s[8:11], s77 offen offset:0 nt
  buffer_load_dwordx4 v[208:211], v3, s[8:11], s77 offen offset:1024 nt
  buffer_load_dwordx4 v[220:223], v11, s[12:15], s80 offen sc1
  buffer_load_dwordx4 v[224:227], v11, s[12:15], s80 offen offset:16 sc1
  s_waitcnt vmcnt(0)
  v_xor_b32 v8, s66, v221
  v_xor_b32 v9, s67, v223
  v_or_b32 v7, v8, v9
  v_xor_b32 v8, s66, v225
  v_xor_b32 v9, s67, v227
  v_or3_b32 v7, v7, v8, v9
  v_cmp_ne_u32 vcc, 0, v7
  s_cbranch_vccz L_pok_30
  s_add_u32 s77, s72, 98304
  buffer_load_dwordx4 v[212:215], v3, s[8:11], s77 offen offset:2048 nt
  buffer_load_dwordx4 v[216:219], v3, s[8:11], s77 offen offset:3072 nt
  buffer_load_dwordx4 v[220:223], v11, s[12:15], s80 offen sc1
  buffer_load_dwordx4 v[224:227], v11, s[12:15], s80 offen offset:16 sc1
  s_waitcnt vmcnt(0)
  v_xor_b32 v8, s66, v221
  v_xor_b32 v9, s67, v223
  v_or_b32 v7, v8, v9
  v_xor_b32 v8, s66, v225
  v_xor_b32 v9, s67, v227
  v_or3_b32 v7, v7, v8, v9
  v_cmp_ne_u32 vcc, 0, v7
  s_cbranch_vccz L_pok_32
L_pl:
  buffer_load_dwordx4 v[220:223], v11, s[12:15], s80 offen sc1
  buffer_load_dwordx4 v[224:227], v11, s[12:15], s80 offen offset:16 sc1
  s_waitcnt vmcnt(0)
  v_xor_b32 v8, s66, v221
  v_xor_b32 v9, s67, v223
  v_or_b32 v7, v8, v9
  v_xor_b32 v8, s66, v225
  v_xor_b32 v9, s67, v227
  v_or3_b32 v7, v7, v8, v9
  v_cmp_ne_u32 vcc, 0, v7
  s_cbranch_vccz L_pok_32
  s_sub_u32 s96, s96, 1
  s_cmp_lg_u32 s96, 0
  s_cbranch_scc1 L_pl
  s_branch L_pok_32
L_pok_6:
  s_mov_b32 s92, 6
  s_branch L_pok
L_pok_8:
  s_mov_b32 s92, 8
  s_branch L_pok
L_pok_10:
  s_mov_b32 s92, 10
  s_branch L_pok
L_pok_12:
  s_mov_b32 s92, 12
  s_branch L_pok
L_pok_14:
  s_mov_b32 s92, 14
  s_branch L_pok
L_pok_16:
  s_mov_b32 s92, 16
  s_branch L_pok
L_pok_18:
  s_mov_b32 s92, 18
  s_branch L_pok
L_pok_20:
  s_mov_b32 s92, 20
  s_branch L_pok
L_pok_22:
  s_mov_b32 s92, 22
  s_branch L_pok
L_pok_24:
  s_mov_b32 s92, 24
  s_branch L_pok
L_pok_26:
  s_mov_b32 s92, 26
  s_branch L_pok
L_pok_28:
  s_mov_b32 s92, 28
  s_branch L_pok
L_pok_30:
  s_mov_b32 s92, 30
  s_branch L_pok
L_pok_32:
  s_mov_b32 s92, 32
  s_branch L_pok
L_pok:
  v_mov_b32 v12, v220
  v_mov_b32 v13, v222
  v_mov_b32 v14, v224
  v_mov_b32 v15, v226
L_pokq:
  ds_write_b128 v242, v[12:15]
  v_mov_b32 v7, 1
  s_waitcnt lgkmcnt(0)
  ds_write_b32 v238, v7
  s_setprio 0
  s_cmp_eq_u32 s92, 6
  s_cbranch_scc1 L_rest_6
  s_cmp_eq_u32 s92, 8
  s_cbranch_scc1 L_rest_8
  s_cmp_eq_u32 s92, 10
  s_cbranch_scc1 L_rest_10
  s_cmp_eq_u32 s92, 12
  s_cbranch_scc1 L_rest_12
  s_cmp_eq_u32 s92, 14
  s_cbranch_scc1 L_rest_14
  s_cmp_eq_u32 s92, 16
  s_cbranch_scc1 L_rest_16
  s_cmp_eq_u32 s92, 18
  s_cbranch_scc1 L_rest_18
  s_cmp_eq_u32 s92, 20
  s_cbranch_scc1 L_rest_20
  s_cmp_eq_u32 s92, 22
  s_cbranch_scc1 L_rest_22
  s_cmp_eq_u32 s92, 24
  s_cbranch_scc1 L_rest_24
  s_cmp_eq_u32 s92, 26
  s_cbranch_scc1 L_rest_26
  s_cmp_eq_u32 s92, 28
  s_cbranch_scc1 L_rest_28
  s_cmp_eq_u32 s92, 30
  s_cbranch_scc1 L_rest_30
  s_cmp_eq_u32 s92, 32
  s_cbranch_scc1 L_rest_32
L_rest_4:
  s_add_u32 s77, s72, 32768
  buffer_load_dwordx4 v[108:111], v2, s[4:7], s77 offen offset:0 nt
  buffer_load_dwordx4 v[112:115], v2, s[4:7], s77 offen offset:1024 nt
L_rest_6:
  s_add_u32 s77, s72, 32768
  buffer_load_dwordx4 v[116:119], v2, s[4:7], s77 offen offset:2048 nt
  buffer_load_dwordx4 v[120:123], v2, s[4:7], s77 offen offset:3072 nt
L_rest_8:
  s_add_u32 s77, s72, 0
  buffer_load_dwordx4 v[156:159], v3, s[8:11], s77 offen offset:0 nt
  buffer_load_dwordx4 v[160:163], v3, s[8:11], s77 offen offset:1024 nt
L_rest_10:
  s_add_u32 s77, s72, 0
  buffer_load_dwordx4 v[164:167], v3, s[8:11], s77 offen offset:2048 nt
  buffer_load_dwordx4 v[168:171], v3, s[8:11], s77 offen offset:3072 nt
L_rest_12:
  s_add_u32 s77, s72, 32768
  buffer_load_dwordx4 v[172:175], v3, s[8:11], s77 offen offset:0 nt
  buffer_load_dwordx4 v[176:179], v3, s[8:11], s77 offen offset:1024 nt
L_rest_14:
  s_add_u32 s77, s72, 32768
  buffer_load_dwordx4 v[180:183], v3, s[8:11], s77 offen offset:2048 nt
  buffer_load_dwordx4 v[184:187], v3, s[8:11], s77 offen offset:3072 nt
L_rest_16:
  s_add_u32 s77, s72, 65536
  buffer_load_dwordx4 v[124:127], v2, s[4:7], s77 offen offset:0 nt
  buffer_load_dwordx4 v[128:131], v2, s[4:7], s77 offen offset:1024 nt
L_rest_18:
  s_add_u32 s77, s72, 65536
  buffer_load_dwordx4 v[132:135], v2, s[4:7], s77 offen offset:2048 nt
  buffer_load_dwordx4 v[136:139], v2, s[4:7], s77 offen offset:3072 nt
L_rest_20:
  s_add_u32 s77, s72, 98304
  buffer_load_dwordx4 v[140:143], v2, s[4:7], s77 offen offset:0 nt
  buffer_load_dwordx4 v[144:147], v2, s[4:7], s77 offen offset:1024 nt
L_rest_22:
  s_add_u32 s77, s72, 98304
  buffer_load_dwordx4 v[148:151], v2, s[4:7], s77 offen offset:2048 nt
  buffer_load_dwordx4 v[152:155], v2, s[4:7], s77 offen offset:3072 nt
L_rest_24:
  s_add_u32 s77, s72, 65536
  buffer_load_dwordx4 v[188:191], v3, s[8:11], s77 offen offset:0 nt
  buffer_load_dwordx4 v[192:195], v3, s[8:11], s77 offen offset:1024 nt
L_rest_26:
  s_add_u32 s77, s72, 65536
  buffer_load_dwordx4 v[196:199], v3, s[8:11], s77 offen offset:2048 nt
  buffer_load_dwordx4 v[200:203], v3, s[8:11], s77 offen offset:3072 nt
L_rest_28:
  s_add_u32 s77, s72, 98304
  buffer_load_dwordx4 v[204:207], v3, s[8:11], s77 offen offset:0 nt
  buffer_load_dwordx4 v[208:211], v3, s[8:11], s77 offen offset:1024 nt
L_rest_30:
  s_add_u32 s77, s72, 98304
  buffer_load_dwordx4 v[212:215], v3, s[8:11], s77 offen offset:2048 nt
  buffer_load_dwordx4 v[216:219], v3, s[8:11], s77 offen offset:3072 nt
L_rest_32:
  ds_read_b128 v[12:15], v242
  s_waitcnt lgkmcnt(0)
  s_mov_b32 s85, 0
.p2align 6
L_loop:
  s_waitcnt vmcnt(8) lgkmcnt(0)
  s_add_u32 s77, s85, 1
  s_lshl_b32 s92, s77, 16
  s_add_u32 s92, s92, s72
  s_cmp_eq_u32 s77, 8
  s_cselect_b32 s92, s61, s92
  s_cmp_lt_u32 s77, s58
  s_cselect_b32 s92, s92, 0x8000000
  s_cmp_eq_u32 s85, 0
  s_cbranch_scc1 L_nk_3
  s_add_u32 s77, s92, 0
  buffer_load_dwordx4 v[124:127], v2, s[4:7], s77 offen offset:0 nt
  buffer_load_dwordx4 v[128:131], v2, s[4:7], s77 offen offset:1024 nt
  buffer_load_dwordx4 v[132:135], v2, s[4:7], s77 offen offset:2048 nt
  buffer_load_dwordx4 v[136:139], v2, s[4:7], s77 offen offset:3072 nt
  s_add_u32 s77, s92, 32768
  buffer_load_dwordx4 v[140:143], v2, s[4:7], s77 offen offset:0 nt
  buffer_load_dwordx4 v[144:147], v2, s[4:7], s77 offen offset:1024 nt
  buffer_load_dwordx4 v[148:151], v2, s[4:7], s77 offen offset:2048 nt
  buffer_load_dwordx4 v[152:155], v2, s[4:7], s77 offen offset:3072 nt
L_nk_3:
  v_mfma_f32_16x16x32_bf16 v[60:63], v[92:95], v[12:15], 0
  v_mfma_f32_16x16x32_bf16 v[64:67], v[96:99], v[12:15], 0
  v_mfma_f32_16x16x32_bf16 v[68:71], v[100:103], v[12:15], 0
  v_mfma_f32_16x16x32_bf16 v[72:75], v[104:107], v[12:15], 0
  v_mfma_f32_16x16x32_bf16 v[76:79], v[108:111], v[12:15], 0
  v_mfma_f32_16x16x32_bf16 v[80:83], v[112:115], v[12:15], 0
  v_mfma_f32_16x16x32_bf16 v[84:87], v[116:119], v[12:15], 0
  v_mfma_f32_16x16x32_bf16 v[88:91], v[120:123], v[12:15], 0
  s_nop 1
  v_mul_f32_dpp v20, v60, v4 quad_perm:[0,0,0,0] row_mask:0xf bank_mask:0xf
  v_fmac_f32_dpp v20, v61, v4 quad_perm:[1,1,1,1] row_mask:0xf bank_mask:0xf
  v_fmac_f32_dpp v20, v62, v4 quad_perm:[2,2,2,2] row_mask:0xf bank_mask:0xf
  v_fmac_f32_dpp v20, v63, v4 quad_perm:[3,3,3,3] row_mask:0xf bank_mask:0xf
  v_mul_f32_dpp v21, v64, v4 quad_perm:[0,0,0,0] row_mask:0xf bank_mask:0xf
  v_fmac_f32_dpp v21, v65, v4 quad_perm:[1,1,1,1] row_mask:0xf bank_mask:0xf
  v_fmac_f32_dpp v21, v66, v4 quad_perm:[2,2,2,2] row_mask:0xf bank_mask:0xf
  v_fmac_f32_dpp v21, v67, v4 quad_perm:[3,3,3,3] row_mask:0xf bank_mask:0xf
  v_mul_f32_dpp v22, v68, v4 quad_perm:[0,0,0,0] row_mask:0xf bank_mask:0xf
  v_fmac_f32_dpp v22, v69, v4 quad_perm:[1,1,1,1] row_mask:0xf bank_mask:0xf
  v_fmac_f32_dpp v22, v70, v4 quad_perm:[2,2,2,2] row_mask:0xf bank_mask:0xf
  v_fmac_f32_dpp v22, v71, v4 quad_perm:[3,3,3,3] row_mask:0xf bank_mask:0xf
  v_mul_f32_dpp v23, v72, v4 quad_perm:[0,0,0,0] row_mask:0xf bank_mask:0xf
  v_fmac_f32_dpp v23, v73, v4 quad_perm:[1,1,1,1] row_mask:0xf bank_mask:0xf
  v_fmac_f32_dpp v23, v74, v4 quad_perm:[2,2,2,2] row_mask:0xf bank_mask:0xf
  v_fmac_f32_dpp v23, v75, v4 quad_perm:[3,3,3,3] row_mask:0xf bank_mask:0xf
  v_mul_f32_dpp v24, v76, v4 quad_perm:[0,0,0,0] row_mask:0xf bank_mask:0xf
  v_fmac_f32_dpp v24, v77, v4 quad_perm:[1,1,1,1] row_mask:0xf bank_mask:0xf
  v_fmac_f32_dpp v24, v78, v4 quad_perm:[2,2,2,2] row_mask:0xf bank_mask:0xf
  v_fmac_f32_dpp v24, v79, v4 quad_perm:[3,3,3,3] row_mask:0xf bank_mask:0xf
  v_mul_f32_dpp v25, v80, v4 quad_perm:[0,0,0,0] row_mask:0xf bank_mask:0xf
  v_fmac_f32_dpp v25, v81, v4 quad_perm:[1,1,1,1] row_mask:0xf bank_mask:0xf
  v_fmac_f32_dpp v25, v82, v4 quad_perm:[2,2,2,2] row_mask:0xf bank_mask:0xf
  v_fmac_f32_dpp v25, v83, v4 quad_perm:[3,3,3,3] row_mask:0xf bank_mask:0xf
  v_mul_f32_dpp v26, v84, v4 quad_perm:[0,0,0,0] row_mask:0xf bank_mask:0xf
  v_fmac_f32_dpp v26, v85, v4 quad_perm:[1,1,1,1] row_mask:0xf bank_mask:0xf
  v_fmac_f32_dpp v26, v86, v4 quad_perm:[2,2,2,2] row_mask:0xf bank_mask:0xf
  v_fmac_f32_dpp v26, v87, v4 quad_perm:[3,3,3,3] row_mask:0xf bank_mask:0xf
  v_mul_f32_dpp v27, v88, v4 quad_perm:[0,0,0,0] row_mask:0xf bank_mask:0xf
  v_fmac_f32_dpp v27, v89, v4 quad_perm:[1,1,1,1] row_mask:0xf bank_mask:0xf
  v_fmac_f32_dpp v27, v90, v4 quad_perm:[2,2,2,2] row_mask:0xf bank_mask:0xf
  v_fmac_f32_dpp v27, v91, v4 quad_perm:[3,3,3,3] row_mask:0xf bank_mask:0xf
  v_max3_f32 v7, v20, v21, v22
  v_max3_f32 v7, v7, v23, v24
  v_max3_f32 v7, v7, v25, v26
  v_max3_f32 v7, v7, v27, v5
  v_mov_b32 v8, v7
  s_nop 1
  v_permlane32_swap_b32 v7, v8
  v_max_f32 v7, v7, v8
  v_mov_b32 v8, v7
  s_nop 1
  v_permlane16_swap_b32 v7, v8
  v_max_f32 v7, v7, v8
  v_sub_f32 v236, v5, v7
  v_exp_f32 v236, v236
  v_mov_b32 v5, v7
  v_sub_f32 v20, v20, v7
  v_sub_f32 v21, v21, v7
  v_sub_f32 v22, v22, v7
  v_sub_f32 v23, v23, v7
  v_sub_f32 v24, v24, v7
  v_sub_f32 v25, v25, v7
  v_sub_f32 v26, v26, v7
  v_sub_f32 v27, v27, v7
  v_exp_f32 v20, v20
  v_exp_f32 v21, v21
  v_exp_f32 v22, v22
  v_exp_f32 v23, v23
  v_exp_f32 v24, v24
  v_exp_f32 v25, v25
  v_exp_f32 v26, v26
  v_exp_f32 v27, v27
  v_mul_f32 v6, v6, v236
  v_pk_mul_f32 v[28:29], v[28:29], v[236:237] op_sel_hi:[1,0]
  v_pk_mul_f32 v[30:31], v[30:31], v[236:237] op_sel_hi:[1,0]
  v_pk_mul_f32 v[32:33], v[32:33], v[236:237] op_sel_hi:[1,0]
  v_pk_mul_f32 v[34:35], v[34:35], v[236:237] op_sel_hi:[1,0]
  v_pk_mul_f32 v[36:37], v[36:37], v[236:237] op_sel_hi:[1,0]
  v_pk_mul_f32 v[38:39], v[38:39], v[236:237] op_sel_hi:[1,0]
  v_pk_mul_f32 v[40:41], v[40:41], v[236:237] op_sel_hi:[1,0]
  v_pk_mul_f32 v[42:43], v[42:43], v[236:237] op_sel_hi:[1,0]
  v_pk_mul_f32 v[44:45], v[44:45], v[236:237] op_sel_hi:[1,0]
  v_pk_mul_f32 v[46:47], v[46:47], v[236:237] op_sel_hi:[1,0]
  v_pk_mul_f32 v[48:49], v[48:49], v[236:237] op_sel_hi:[1,0]
  v_pk_mul_f32 v[50:51], v[50:51], v[236:237] op_sel_hi:[1,0]
  v_pk_mul_f32 v[52:53], v[52:53], v[236:237] op_sel_hi:[1,0]
  v_pk_mul_f32 v[54:55], v[54:55], v[236:237] op_sel_hi:[1,0]
  v_pk_mul_f32 v[56:57], v[56:57], v[236:237] op_sel_hi:[1,0]
  v_pk_mul_f32 v[58:59], v[58:59], v[236:237] op_sel_hi:[1,0]
  v_add_f32 v6, v6, v20
  v_add_f32 v6, v6, v21
  v_add_f32 v6, v6, v22
  v_add_f32 v6, v6, v23
  v_add_f32 v6, v6, v24
  v_add_f32 v6, v6, v25
  v_add_f32 v6, v6, v26
  v_add_f32 v6, v6, v27
  v_cvt_pk_bf16_f32 v16, v20, v21
  v_cvt_pk_bf16_f32 v17, v22, v23
  v_cvt_pk_bf16_f32 v18, v24, v25
  v_cvt_pk_bf16_f32 v19, v26, v27
  s_waitcnt vmcnt(8)
  s_cmp_eq_u32 s85, 0
  s_cbranch_scc1 L_nv_4
  s_add_u32 s77, s92, 0
  buffer_load_dwordx4 v[188:191], v3, s[8:11], s77 offen offset:0 nt
  buffer_load_dwordx4 v[192:195], v3, s[8:11], s77 offen offset:1024 nt
  buffer_load_dwordx4 v[196:199], v3, s[8:11], s77 offen offset:2048 nt
  buffer_load_dwordx4 v[200:203], v3, s[8:11], s77 offen offset:3072 nt
  s_add_u32 s77, s92, 32768
  buffer_load_dwordx4 v[204:207], v3, s[8:11], s77 offen offset:0 nt
  buffer_load_dwordx4 v[208:211], v3, s[8:11], s77 offen offset:1024 nt
  buffer_load_dwordx4 v[212:215], v3, s[8:11], s77 offen offset:2048 nt
  buffer_load_dwordx4 v[216:219], v3, s[8:11], s77 offen offset:3072 nt
L_nv_4:
  v_perm_b32 v60, v160, v156, s94
  v_perm_b32 v61, v168, v164, s94
  v_perm_b32 v62, v176, v172, s94
  v_perm_b32 v63, v184, v180, s94
  v_perm_b32 v64, v160, v156, s95
  v_perm_b32 v65, v168, v164, s95
  v_perm_b32 v66, v176, v172, s95
  v_perm_b32 v67, v184, v180, s95
  v_perm_b32 v68, v161, v157, s94
  v_perm_b32 v69, v169, v165, s94
  v_perm_b32 v70, v177, v173, s94
  v_perm_b32 v71, v185, v181, s94
  v_perm_b32 v72, v161, v157, s95
  v_perm_b32 v73, v169, v165, s95
  v_perm_b32 v74, v177, v173, s95
  v_perm_b32 v75, v185, v181, s95
  v_perm_b32 v76, v162, v158, s94
  v_perm_b32 v77, v170, v166, s94
  v_perm_b32 v78, v178, v174, s94
  v_perm_b32 v79, v186, v182, s94
  v_perm_b32 v80, v162, v158, s95
  v_perm_b32 v81, v170, v166, s95
  v_perm_b32 v82, v178, v174, s95
  v_perm_b32 v83, v186, v182, s95
  v_perm_b32 v84, v163, v159, s94
  v_perm_b32 v85, v171, v167, s94
  v_perm_b32 v86, v179, v175, s94
  v_perm_b32 v87, v187, v183, s94
  v_perm_b32 v88, v163, v159, s95
  v_perm_b32 v89, v171, v167, s95
  v_perm_b32 v90, v179, v175, s95
  v_perm_b32 v91, v187, v183, s95
  s_nop 0
  v_mfma_f32_16x16x32_bf16 v[28:31], v[60:63], v[16:19], v[28:31]
  v_mfma_f32_16x16x32_bf16 v[32:35], v[64:67], v[16:19], v[32:35]
  v_mfma_f32_16x16x32_bf16 v[36:39], v[68:71], v[16:19], v[36:39]
  v_mfma_f32_16x16x32_bf16 v[40:43], v[72:75], v[16:19], v[40:43]
  v_mfma_f32_16x16x32_bf16 v[44:47], v[76:79], v[16:19], v[44:47]
  v_mfma_f32_16x16x32_bf16 v[48:51], v[80:83], v[16:19], v[48:51]
  v_mfma_f32_16x16x32_bf16 v[52:55], v[84:87], v[16:19], v[52:55]
  v_mfma_f32_16x16x32_bf16 v[56:59], v[88:91], v[16:19], v[56:59]
  s_add_u32 s85, s85, 1
  s_cmp_eq_u32 s85, 1
  s_cbranch_scc1 L_x_issue
  s_cmp_ge_u32 s85, s58
  s_cbranch_scc1 L_loop_end
L_loop_b:
  s_waitcnt vmcnt(8) lgkmcnt(0)
  s_add_u32 s77, s85, 1
  s_lshl_b32 s92, s77, 16
  s_add_u32 s92, s92, s72
  s_cmp_eq_u32 s77, 8
  s_cselect_b32 s92, s61, s92
  s_cmp_lt_u32 s77, s58
  s_cselect_b32 s92, s92, 0x8000000
  s_cmp_eq_u32 s85, 0
  s_cbranch_scc1 L_nk_5
  s_add_u32 s77, s92, 0
  buffer_load_dwordx4 v[92:95], v2, s[4:7], s77 offen offset:0 nt
  buffer_load_dwordx4 v[96:99], v2, s[4:7], s77 offen offset:1024 nt
  buffer_load_dwordx4 v[100:103], v2, s[4:7], s77 offen offset:2048 nt
  buffer_load_dwordx4 v[104:107], v2, s[4:7], s77 offen offset:3072 nt
  s_add_u32 s77, s92, 32768
  buffer_load_dwordx4 v[108:111], v2, s[4:7], s77 offen offset:0 nt
  buffer_load_dwordx4 v[112:115], v2, s[4:7], s77 offen offset:1024 nt
  buffer_load_dwordx4 v[116:119], v2, s[4:7], s77 offen offset:2048 nt
  buffer_load_dwordx4 v[120:123], v2, s[4:7], s77 offen offset:3072 nt
L_nk_5:
  v_mfma_f32_16x16x32_bf16 v[60:63], v[124:127], v[12:15], 0
  v_mfma_f32_16x16x32_bf16 v[64:67], v[128:131], v[12:15], 0
  v_mfma_f32_16x16x32_bf16 v[68:71], v[132:135], v[12:15], 0
  v_mfma_f32_16x16x32_bf16 v[72:75], v[136:139], v[12:15], 0
  v_mfma_f32_16x16x32_bf16 v[76:79], v[140:143], v[12:15], 0
  v_mfma_f32_16x16x32_bf16 v[80:83], v[144:147], v[12:15], 0
  v_mfma_f32_16x16x32_bf16 v[84:87], v[148:151], v[12:15], 0
  v_mfma_f32_16x16x32_bf16 v[88:91], v[152:155], v[12:15], 0
  s_nop 1
  v_mul_f32_dpp v20, v60, v4 quad_perm:[0,0,0,0] row_mask:0xf bank_mask:0xf
  v_fmac_f32_dpp v20, v61, v4 quad_perm:[1,1,1,1] row_mask:0xf bank_mask:0xf
  v_fmac_f32_dpp v20, v62, v4 quad_perm:[2,2,2,2] row_mask:0xf bank_mask:0xf
  v_fmac_f32_dpp v20, v63, v4 quad_perm:[3,3,3,3] row_mask:0xf bank_mask:0xf
  v_mul_f32_dpp v21, v64, v4 quad_perm:[0,0,0,0] row_mask:0xf bank_mask:0xf
  v_fmac_f32_dpp v21, v65, v4 quad_perm:[1,1,1,1] row_mask:0xf bank_mask:0xf
  v_fmac_f32_dpp v21, v66, v4 quad_perm:[2,2,2,2] row_mask:0xf bank_mask:0xf
  v_fmac_f32_dpp v21, v67, v4 quad_perm:[3,3,3,3] row_mask:0xf bank_mask:0xf
  v_mul_f32_dpp v22, v68, v4 quad_perm:[0,0,0,0] row_mask:0xf bank_mask:0xf
  v_fmac_f32_dpp v22, v69, v4 quad_perm:[1,1,1,1] row_mask:0xf bank_mask:0xf
  v_fmac_f32_dpp v22, v70, v4 quad_perm:[2,2,2,2] row_mask:0xf bank_mask:0xf
  v_fmac_f32_dpp v22, v71, v4 quad_perm:[3,3,3,3] row_mask:0xf bank_mask:0xf
  v_mul_f32_dpp v23, v72, v4 quad_perm:[0,0,0,0] row_mask:0xf bank_mask:0xf
  v_fmac_f32_dpp v23, v73, v4 quad_perm:[1,1,1,1] row_mask:0xf bank_mask:0xf
  v_fmac_f32_dpp v23, v74, v4 quad_perm:[2,2,2,2] row_mask:0xf bank_mask:0xf
  v_fmac_f32_dpp v23, v75, v4 quad_perm:[3,3,3,3] row_mask:0xf bank_mask:0xf
  v_mul_f32_dpp v24, v76, v4 quad_perm:[0,0,0,0] row_mask:0xf bank_mask:0xf
  v_fmac_f32_dpp v24, v77, v4 quad_perm:[1,1,1,1] row_mask:0xf bank_mask:0xf
  v_fmac_f32_dpp v24, v78, v4 quad_perm:[2,2,2,2] row_mask:0xf bank_mask:0xf
  v_fmac_f32_dpp v24, v79, v4 quad_perm:[3,3,3,3] row_mask:0xf bank_mask:0xf
  v_mul_f32_dpp v25, v80, v4 quad_perm:[0,0,0,0] row_mask:0xf bank_mask:0xf
  v_fmac_f32_dpp v25, v81, v4 quad_perm:[1,1,1,1] row_mask:0xf bank_mask:0xf
  v_fmac_f32_dpp v25, v82, v4 quad_perm:[2,2,2,2] row_mask:0xf bank_mask:0xf
  v_fmac_f32_dpp v25, v83, v4 quad_perm:[3,3,3,3] row_mask:0xf bank_mask:0xf
  v_mul_f32_dpp v26, v84, v4 quad_perm:[0,0,0,0] row_mask:0xf bank_mask:0xf
  v_fmac_f32_dpp v26, v85, v4 quad_perm:[1,1,1,1] row_mask:0xf bank_mask:0xf
  v_fmac_f32_dpp v26, v86, v4 quad_perm:[2,2,2,2] row_mask:0xf bank_mask:0xf
  v_fmac_f32_dpp v26, v87, v4 quad_perm:[3,3,3,3] row_mask:0xf bank_mask:0xf
  v_mul_f32_dpp v27, v88, v4 quad_perm:[0,0,0,0] row_mask:0xf bank_mask:0xf
  v_fmac_f32_dpp v27, v89, v4 quad_perm:[1,1,1,1] row_mask:0xf bank_mask:0xf
  v_fmac_f32_dpp v27, v90, v4 quad_perm:[2,2,2,2] row_mask:0xf bank_mask:0xf
  v_fmac_f32_dpp v27, v91, v4 quad_perm:[3,3,3,3] row_mask:0xf bank_mask:0xf
  v_max3_f32 v7, v20, v21, v22
  v_max3_f32 v7, v7, v23, v24
  v_max3_f32 v7, v7, v25, v26
  v_max3_f32 v7, v7, v27, v5
  v_mov_b32 v8, v7
  s_nop 1
  v_permlane32_swap_b32 v7, v8
  v_max_f32 v7, v7, v8
  v_mov_b32 v8, v7
  s_nop 1
  v_permlane16_swap_b32 v7, v8
  v_max_f32 v7, v7, v8
  v_sub_f32 v236, v5, v7
  v_exp_f32 v236, v236
  v_mov_b32 v5, v7
  v_sub_f32 v20, v20, v7
  v_sub_f32 v21, v21, v7
  v_sub_f32 v22, v22, v7
  v_sub_f32 v23, v23, v7
  v_sub_f32 v24, v24, v7
  v_sub_f32 v25, v25, v7
  v_sub_f32 v26, v26, v7
  v_sub_f32 v27, v27, v7
  v_exp_f32 v20, v20
  v_exp_f32 v21, v21
  v_exp_f32 v22, v22
  v_exp_f32 v23, v23
  v_exp_f32 v24, v24
  v_exp_f32 v25, v25
  v_exp_f32 v26, v26
  v_exp_f32 v27, v27
  v_mul_f32 v6, v6, v236
  v_pk_mul_f32 v[28:29], v[28:29], v[236:237] op_sel_hi:[1,0]
  v_pk_mul_f32 v[30:31], v[30:31], v[236:237] op_sel_hi:[1,0]
  v_pk_mul_f32 v[32:33], v[32:33], v[236:237] op_sel_hi:[1,0]
  v_pk_mul_f32 v[34:35], v[34:35], v[236:237] op_sel_hi:[1,0]
  v_pk_mul_f32 v[36:37], v[36:37], v[236:237] op_sel_hi:[1,0]
  v_pk_mul_f32 v[38:39], v[38:39], v[236:237] op_sel_hi:[1,0]
  v_pk_mul_f32 v[40:41], v[40:41], v[236:237] op_sel_hi:[1,0]
  v_pk_mul_f32 v[42:43], v[42:43], v[236:237] op_sel_hi:[1,0]
  v_pk_mul_f32 v[44:45], v[44:45], v[236:237] op_sel_hi:[1,0]
  v_pk_mul_f32 v[46:47], v[46:47], v[236:237] op_sel_hi:[1,0]
  v_pk_mul_f32 v[48:49], v[48:49], v[236:237] op_sel_hi:[1,0]
  v_pk_mul_f32 v[50:51], v[50:51], v[236:237] op_sel_hi:[1,0]
  v_pk_mul_f32 v[52:53], v[52:53], v[236:237] op_sel_hi:[1,0]
  v_pk_mul_f32 v[54:55], v[54:55], v[236:237] op_sel_hi:[1,0]
  v_pk_mul_f32 v[56:57], v[56:57], v[236:237] op_sel_hi:[1,0]
  v_pk_mul_f32 v[58:59], v[58:59], v[236:237] op_sel_hi:[1,0]
  v_add_f32 v6, v6, v20
  v_add_f32 v6, v6, v21
  v_add_f32 v6, v6, v22
  v_add_f32 v6, v6, v23
  v_add_f32 v6, v6, v24
  v_add_f32 v6, v6, v25
  v_add_f32 v6, v6, v26
  v_add_f32 v6, v6, v27
  v_cvt_pk_bf16_f32 v16, v20, v21
  v_cvt_pk_bf16_f32 v17, v22, v23
  v_cvt_pk_bf16_f32 v18, v24, v25
  v_cvt_pk_bf16_f32 v19, v26, v27
  s_waitcnt vmcnt(8)
  s_cmp_eq_u32 s85, 0
  s_cbranch_scc1 L_nv_6
  s_add_u32 s77, s92, 0
  buffer_load_dwordx4 v[156:159], v3, s[8:11], s77 offen offset:0 nt
  buffer_load_dwordx4 v[160:163], v3, s[8:11], s77 offen offset:1024 nt
  buffer_load_dwordx4 v[164:167], v3, s[8:11], s77 offen offset:2048 nt
  buffer_load_dwordx4 v[168:171], v3, s[8:11], s77 offen offset:3072 nt
  s_add_u32 s77, s92, 32768
  buffer_load_dwordx4 v[172:175], v3, s[8:11], s77 offen offset:0 nt
  buffer_load_dwordx4 v[176:179], v3, s[8:11], s77 offen offset:1024 nt
  buffer_load_dwordx4 v[180:183], v3, s[8:11], s77 offen offset:2048 nt
  buffer_load_dwordx4 v[184:187], v3, s[8:11], s77 offen offset:3072 nt
L_nv_6:
  v_perm_b32 v60, v192, v188, s94
  v_perm_b32 v61, v200, v196, s94
  v_perm_b32 v62, v208, v204, s94
  v_perm_b32 v63, v216, v212, s94
  v_perm_b32 v64, v192, v188, s95
  v_perm_b32 v65, v200, v196, s95
  v_perm_b32 v66, v208, v204, s95
  v_perm_b32 v67, v216, v212, s95
  v_perm_b32 v68, v193, v189, s94
  v_perm_b32 v69, v201, v197, s94
  v_perm_b32 v70, v209, v205, s94
  v_perm_b32 v71, v217, v213, s94
  v_perm_b32 v72, v193, v189, s95
  v_perm_b32 v73, v201, v197, s95
  v_perm_b32 v74, v209, v205, s95
  v_perm_b32 v75, v217, v213, s95
  v_perm_b32 v76, v194, v190, s94
  v_perm_b32 v77, v202, v198, s94
  v_perm_b32 v78, v210, v206, s94
  v_perm_b32 v79, v218, v214, s94
  v_perm_b32 v80, v194, v190, s95
  v_perm_b32 v81, v202, v198, s95
  v_perm_b32 v82, v210, v206, s95
  v_perm_b32 v83, v218, v214, s95
  v_perm_b32 v84, v195, v191, s94
  v_perm_b32 v85, v203, v199, s94
  v_perm_b32 v86, v211, v207, s94
  v_perm_b32 v87, v219, v215, s94
  v_perm_b32 v88, v195, v191, s95
  v_perm_b32 v89, v203, v199, s95
  v_perm_b32 v90, v211, v207, s95
  v_perm_b32 v91, v219, v215, s95
  s_nop 0
  v_mfma_f32_16x16x32_bf16 v[28:31], v[60:63], v[16:19], v[28:31]
  v_mfma_f32_16x16x32_bf16 v[32:35], v[64:67], v[16:19], v[32:35]
  v_mfma_f32_16x16x32_bf16 v[36:39], v[68:71], v[16:19], v[36:39]
  v_mfma_f32_16x16x32_bf16 v[40:43], v[72:75], v[16:19], v[40:43]
  v_mfma_f32_16x16x32_bf16 v[44:47], v[76:79], v[16:19], v[44:47]
  v_mfma_f32_16x16x32_bf16 v[48:51], v[80:83], v[16:19], v[48:51]
  v_mfma_f32_16x16x32_bf16 v[52:55], v[84:87], v[16:19], v[52:55]
  v_mfma_f32_16x16x32_bf16 v[56:59], v[88:91], v[16:19], v[56:59]
  s_add_u32 s85, s85, 1
  s_cmp_eq_u32 s85, 2
  s_cbranch_scc1 L_x_process
L_loop_c:
  s_cmp_lt_u32 s85, s58
  s_cbranch_scc1 L_loop
L_loop_end:
  v_mov_b32 v8, v6
  s_nop 1
  v_permlane32_swap_b32 v6, v8
  v_add_f32 v6, v6, v8
  v_mov_b32 v8, v6
  s_nop 1
  v_permlane16_swap_b32 v6, v8
  v_add_f32 v237, v6, v8
  v_mov_b32 v236, v5
  v_bfe_u32 v7, v1, 2, 2
  v_lshrrev_b32 v8, 4, v1
  v_lshlrev_b32 v9, 9, v7
  v_lshl_add_u32 v9, v8, 7, v9
  s_lshl_b32 s77, s3, 11
  s_add_u32 s77, s77, 65536
  v_add_u32 v9, s77, v9
  s_lshl_b32 s77, s3, 3
  s_add_u32 s77, s77, 81920
  v_lshl_add_u32 v10, v7, 6, s77
  s_mov_b64 exec, s[86:87]
  ds_write_b128 v9, v[28:31] offset:0
  ds_write_b128 v9, v[32:35] offset:16
  ds_write_b128 v9, v[36:39] offset:32
  ds_write_b128 v9, v[40:43] offset:48
  ds_write_b128 v9, v[44:47] offset:64
  ds_write_b128 v9, v[48:51] offset:80
  ds_write_b128 v9, v[52:55] offset:96
  ds_write_b128 v9, v[56:59] offset:112
  s_mov_b64 exec, 0x1111
  ds_write_b64 v10, v[236:237]
  s_mov_b64 exec, -1
  s_cmp_lt_u32 s3, 4
  s_cbranch_scc1 L_t1_old
  s_waitcnt lgkmcnt(0)
  s_barrier
  s_cmp_eq_u32 s3, 4
  s_cbranch_scc1 L_final
  s_branch L_end2
L_t1_old:
  s_waitcnt vmcnt(0)
  s_cmp_gt_u32 s3, 3
  s_cbranch_scc1 L_nowo
  v_lshrrev_b32 v8, 4, v1
  v_bfe_u32 v7, v1, 3, 1
  v_and_b32 v9, 7, v1
  v_lshl_add_u32 v10, v8, 1, v7
  v_lshlrev_b32 v10, 10, v10
  v_lshl_add_u32 v243, v9, 4, v10
  s_and_b32 s80, s3, 3
  s_lshl_b32 s79, s71, 17
  s_lshl_b32 s77, s80, 15
  s_add_u32 s79, s79, s77
  s_lshl_b32 s77, s84, 7
  s_add_u32 s79, s79, s77
  s_lshl_b32 s80, s80, 12
  s_add_u32 s77, s79, 0
  buffer_load_dwordx4 v[92:95], v243, s[24:27], s77 offen nt
  s_add_u32 s77, s79, 8192
  buffer_load_dwordx4 v[96:99], v243, s[24:27], s77 offen nt
  s_add_u32 s77, s79, 16384
  buffer_load_dwordx4 v[100:103], v243, s[24:27], s77 offen nt
  s_add_u32 s77, s79, 24576
  buffer_load_dwordx4 v[104:107], v243, s[24:27], s77 offen nt
L_nowo:
  v_lshlrev_b32 v7, 3, v0
  v_add_u32 v7, 65536, v7
  s_lshl_b32 s77, s3, 6
  s_add_u32 s77, s77, 81920
  v_mov_b32 v8, s77
  s_lshr_b32 s77, s72, 19
  s_lshl_b32 s78, s77, 11
  s_add_u32 s78, s78, 524288
  s_lshr_b32 s79, s77, 2
  s_lshl_b32 s79, s79, 7
  s_lshl_b32 s77, s70, 3
  s_add_u32 s79, s79, s77
  s_lshl_b32 s77, s3, 5
  s_add_u32 s79, s79, s77
  s_add_u32 s79, s79, 1048576
  v_lshlrev_b32 v238, 3, v0
  v_mov_b32 v221, s66
  v_mov_b32 v223, s67
  s_bitcmp1_b32 s70, 0
  s_cselect_b32 s77, s67, s66
  v_mov_b32 v225, s77
  s_waitcnt lgkmcnt(0)
  s_barrier
  s_cmp_gt_u32 s3, 4
  s_cbranch_scc1 L_end2
  s_cmp_eq_u32 s3, 4
  s_cbranch_scc1 L_final
  ds_read_b128 v[28:31], v8 offset:0
  ds_read_b128 v[32:35], v8 offset:16
  ds_read_b128 v[36:39], v8 offset:32
  ds_read_b128 v[40:43], v8 offset:48
  ds_read_b64 v[44:45], v7 offset:0
  ds_read_b64 v[46:47], v7 offset:2048
  ds_read_b64 v[48:49], v7 offset:4096
  ds_read_b64 v[50:51], v7 offset:6144
  ds_read_b64 v[52:53], v7 offset:8192
  ds_read_b64 v[54:55], v7 offset:10240
  ds_read_b64 v[56:57], v7 offset:12288
  ds_read_b64 v[58:59], v7 offset:14336
  s_waitcnt lgkmcnt(8)
  v_max3_f32 v236, v28, v30, v32
  v_max3_f32 v236, v236, v34, v36
  v_max3_f32 v236, v236, v38, v40
  v_max_f32 v236, v236, v42
  v_sub_f32 v20, v28, v236
  v_sub_f32 v21, v30, v236
  v_sub_f32 v22, v32, v236
  v_sub_f32 v23, v34, v236
  v_sub_f32 v24, v36, v236
  v_sub_f32 v25, v38, v236
  v_sub_f32 v26, v40, v236
  v_sub_f32 v27, v42, v236
  v_exp_f32 v20, v20
  v_exp_f32 v21, v21
  v_exp_f32 v22, v22
  v_exp_f32 v23, v23
  v_exp_f32 v24, v24
  v_exp_f32 v25, v25
  v_exp_f32 v26, v26
  v_exp_f32 v27, v27
  v_mul_f32 v237, v20, v29
  v_fmac_f32 v237, v21, v31
  v_fmac_f32 v237, v22, v33
  v_fmac_f32 v237, v23, v35
  v_fmac_f32 v237, v24, v37
  v_fmac_f32 v237, v25, v39
  v_fmac_f32 v237, v26, v41
  v_fmac_f32 v237, v27, v43
  v_rcp_f32 v9, v237
  v_log_f32 v10, v237
  s_waitcnt lgkmcnt(0)
  v_mul_f32 v7, v20, v44
  v_mul_f32 v8, v20, v45
  v_fmac_f32 v7, v21, v46
  v_fmac_f32 v8, v21, v47
  v_fmac_f32 v7, v22, v48
  v_fmac_f32 v8, v22, v49
  v_fmac_f32 v7, v23, v50
  v_fmac_f32 v8, v23, v51
  v_fmac_f32 v7, v24, v52
  v_fmac_f32 v8, v24, v53
  v_fmac_f32 v7, v25, v54
  v_fmac_f32 v8, v25, v55
  v_fmac_f32 v7, v26, v56
  v_fmac_f32 v8, v26, v57
  v_fmac_f32 v7, v27, v58
  v_fmac_f32 v8, v27, v59
  v_mul_f32 v7, v7, v9
  v_mul_f32 v8, v8, v9
  v_cvt_pk_bf16_f32 v220, v7, v8
  v_add_f32 v224, v236, v10
  v_mov_b32 v10, 0
  v_mov_b32_dpp v222, v220 quad_perm:[1,1,3,3] row_mask:0xf bank_mask:0xf
  s_mov_b32 exec_lo, 0x55555555
  s_mov_b32 exec_hi, 0x55555555
  buffer_store_dwordx4 v[220:223], v238, s[12:15], s78 offen sc1
  s_mov_b64 exec, 1
  buffer_store_dwordx2 v[224:225], v10, s[12:15], s79 offen sc1
  s_mov_b64 exec, -1
  v_and_b32 v7, 7, v1
  v_lshrrev_b32 v8, 4, v1
  v_bfe_u32 v9, v1, 3, 1
  v_lshlrev_b32 v238, 16, v7
  v_lshl_add_u32 v238, v8, 5, v238
  v_lshl_add_u32 v238, v9, 4, v238
  v_lshlrev_b32 v239, 10, v7
  s_lshr_b32 s77, s71, 2
  s_and_b32 s80, s71, 3
  s_lshl_b32 s78, s77, 13
  s_lshl_b32 s79, s77, 7
  s_lshl_b32 s77, s80, 9
  s_add_u32 s78, s78, s77
  s_lshl_b32 s77, s3, 7
  s_add_u32 s78, s78, s77
  s_add_u32 s78, s78, 524288
  s_add_u32 s92, s78, 4096
  s_lshl_b32 s77, s80, 5
  s_add_u32 s79, s79, s77
  s_add_u32 s79, s79, 1048576
  buffer_load_dwordx4 v[172:175], v239, s[12:15], s79 offen sc1
  buffer_load_dwordx4 v[176:179], v239, s[12:15], s79 offen offset:16 sc1
  s_waitcnt vmcnt(4)
  v_perm_b32 v108, v96, v92, s94
  v_perm_b32 v109, v104, v100, s94
  v_perm_b32 v110, v96, v92, s95
  v_perm_b32 v111, v104, v100, s95
  v_perm_b32 v112, v97, v93, s94
  v_perm_b32 v113, v105, v101, s94
  v_perm_b32 v114, v97, v93, s95
  v_perm_b32 v115, v105, v101, s95
  v_perm_b32 v116, v98, v94, s94
  v_perm_b32 v117, v106, v102, s94
  v_perm_b32 v118, v98, v94, s95
  v_perm_b32 v119, v106, v102, s95
  v_perm_b32 v120, v99, v95, s94
  v_perm_b32 v121, v107, v103, s94
  v_perm_b32 v122, v99, v95, s95
  v_perm_b32 v123, v107, v103, s95
  v_lshrrev_b32 v7, 5, v1
  v_bfe_u32 v8, v1, 4, 1
  v_and_b32 v9, 7, v1
  v_lshlrev_b32 v7, 11, v7
  v_lshl_add_u32 v7, v8, 7, v7
  v_lshl_add_u32 v7, v9, 8, v7
  s_and_b32 s77, s3, 3
  s_lshl_b32 s77, s77, 12
  s_add_u32 s77, s77, 40960
  v_add_u32 v9, s77, v7
  v_mov_b32 v240, v9
  v_lshlrev_b32 v241, 3, v0
  v_add_u32 v241, 40960, v241
  ds_read_b64 v[76:77], v241 offset:16384
  ds_read_b64 v[78:79], v241 offset:18432
  ds_read_b64 v[80:81], v241 offset:20480
  ds_read_b64 v[82:83], v241 offset:22528
  v_lshrrev_b32 v7, 5, v0
  v_bfe_u32 v8, v0, 3, 2
  v_lshl_add_u32 v7, v7, 5, v8
  v_and_b32 v8, 7, v0
  v_lshlrev_b32 v8, 4, v8
  v_lshl_add_u32 v242, v7, 12, v8
  s_lshl_b32 s80, s84, 14
  s_lshl_b32 s77, s71, 7
  s_add_u32 s80, s80, s77
  s_add_u32 s80, s80, 2097152
  s_waitcnt lgkmcnt(0)
  v_add_f32 v76, v76, v78
  v_add_f32 v80, v80, v82
  v_add_f32 v76, v76, v80
  v_add_f32 v77, v77, v79
  v_add_f32 v81, v81, v83
  v_add_f32 v77, v77, v81
  s_cmp_lg_u32 s3, 0
  s_cbranch_scc1 L_fast
  s_mov_b32 s96, 100000
L_slow:
  s_waitcnt vmcnt(0)
  v_xor_b32 v8, s66, v173
  v_xor_b32 v9, s67, v175
  v_or_b32 v7, v8, v9
  v_xor_b32 v8, s66, v177
  v_xor_b32 v9, s67, v179
  v_or3_b32 v7, v7, v8, v9
  v_cmp_ne_u32 vcc, 0, v7
  s_bcnt0_i32_b64 s77, vcc
  s_cmp_ge_u32 s77, 32
  s_cbranch_scc1 L_fast
  s_sleep 24
  buffer_load_dwordx4 v[172:175], v239, s[12:15], s79 offen sc1
  buffer_load_dwordx4 v[176:179], v239, s[12:15], s79 offen offset:16 sc1
  s_sub_u32 s96, s96, 1
  s_cmp_lg_u32 s96, 0
  s_cbranch_scc1 L_slow
L_fast:
  s_barrier
  s_mov_b32 s96, 400000
L_gat_chk:
  buffer_load_dwordx4 v[156:159], v238, s[12:15], s78 offen offset:0 sc1
  buffer_load_dwordx4 v[160:163], v238, s[12:15], s78 offen offset:2048 sc1
  buffer_load_dwordx4 v[164:167], v238, s[12:15], s92 offen offset:0 sc1
  buffer_load_dwordx4 v[168:171], v238, s[12:15], s92 offen offset:2048 sc1
  buffer_load_dwordx4 v[172:175], v239, s[12:15], s79 offen sc1
  buffer_load_dwordx4 v[176:179], v239, s[12:15], s79 offen offset:16 sc1
  s_waitcnt vmcnt(0)
  s_mov_b64 exec, -1
  v_xor_b32 v8, s66, v157
  v_xor_b32 v9, s67, v159
  v_or_b32 v7, v8, v9
  v_xor_b32 v8, s66, v161
  v_xor_b32 v9, s67, v163
  v_or3_b32 v7, v7, v8, v9
  v_xor_b32 v8, s66, v165
  v_xor_b32 v9, s67, v167
  v_or3_b32 v7, v7, v8, v9
  v_xor_b32 v8, s66, v169
  v_xor_b32 v9, s67, v171
  v_or3_b32 v7, v7, v8, v9
  v_xor_b32 v8, s66, v173
  v_xor_b32 v9, s67, v175
  v_or3_b32 v7, v7, v8, v9
  v_xor_b32 v8, s66, v177
  v_xor_b32 v9, s67, v179
  v_or3_b32 v7, v7, v8, v9
  v_cmp_ne_u32 vcc, 0, v7
  s_cbranch_vccz L_gat_ok
  s_bcnt1_i32_b64 s77, vcc
  s_mov_b64 exec, vcc
  s_cmp_le_u32 s77, 32
  s_cbranch_scc1 L_gat_ns
  s_sleep 8
L_gat_ns:
  s_sub_u32 s96, s96, 1
  s_cmp_lg_u32 s96, 0
  s_cbranch_scc1 L_gat_chk
  s_mov_b64 exec, -1
L_gat_ok:
  v_max3_f32 v7, v172, v174, v176
  v_max_f32 v7, v7, v178
  v_sub_f32 v172, v172, v7
  v_sub_f32 v174, v174, v7
  v_sub_f32 v176, v176, v7
  v_sub_f32 v178, v178, v7
  v_exp_f32 v172, v172
  v_exp_f32 v174, v174
  v_exp_f32 v176, v176
  v_exp_f32 v178, v178
  s_nop 0
  v_add_f32 v7, v172, v174
  v_add_f32 v8, v176, v178
  v_add_f32 v7, v7, v8
  v_rcp_f32 v7, v7
  s_nop 0
  v_mul_f32 v7, v7, v244
  v_mul_f32 v172, v172, v7
  v_mul_f32 v174, v174, v7
  v_mul_f32 v176, v176, v7
  v_mul_f32 v178, v178, v7
  v_lshlrev_b32 v7, 16, v156
  v_and_b32 v8, 0xffff0000, v156
  v_mul_f32 v20, v7, v172
  v_mul_f32 v21, v8, v172
  v_lshlrev_b32 v7, 16, v158
  v_and_b32 v8, 0xffff0000, v158
  v_mul_f32 v22, v7, v172
  v_mul_f32 v23, v8, v172
  v_lshlrev_b32 v7, 16, v160
  v_and_b32 v8, 0xffff0000, v160
  v_fmac_f32 v20, v7, v174
  v_fmac_f32 v21, v8, v174
  v_lshlrev_b32 v7, 16, v162
  v_and_b32 v8, 0xffff0000, v162
  v_fmac_f32 v22, v7, v174
  v_fmac_f32 v23, v8, v174
  v_lshlrev_b32 v7, 16, v164
  v_and_b32 v8, 0xffff0000, v164
  v_fmac_f32 v20, v7, v176
  v_fmac_f32 v21, v8, v176
  v_lshlrev_b32 v7, 16, v166
  v_and_b32 v8, 0xffff0000, v166
  v_fmac_f32 v22, v7, v176
  v_fmac_f32 v23, v8, v176
  v_lshlrev_b32 v7, 16, v168
  v_and_b32 v8, 0xffff0000, v168
  v_fmac_f32 v20, v7, v178
  v_fmac_f32 v21, v8, v178
  v_lshlrev_b32 v7, 16, v170
  v_and_b32 v8, 0xffff0000, v170
  v_fmac_f32 v22, v7, v178
  v_fmac_f32 v23, v8, v178
  v_cvt_pk_bf16_f32 v16, v20, v21
  v_cvt_pk_bf16_f32 v17, v22, v23
  s_nop 1
  v_mfma_f32_16x16x16_bf16 v[188:191], v[108:109], v[16:17], 0
  v_mfma_f32_16x16x16_bf16 v[192:195], v[110:111], v[16:17], 0
  v_mfma_f32_16x16x16_bf16 v[196:199], v[112:113], v[16:17], 0
  v_mfma_f32_16x16x16_bf16 v[200:203], v[114:115], v[16:17], 0
  v_mfma_f32_16x16x16_bf16 v[204:207], v[116:117], v[16:17], 0
  v_mfma_f32_16x16x16_bf16 v[208:211], v[118:119], v[16:17], 0
  v_mfma_f32_16x16x16_bf16 v[212:215], v[120:121], v[16:17], 0
  v_mfma_f32_16x16x16_bf16 v[216:219], v[122:123], v[16:17], 0
  s_nop 3
  s_mov_b64 exec, s[90:91]
  ds_write_b128 v240, v[188:191] offset:0
  ds_write_b128 v240, v[192:195] offset:16
  ds_write_b128 v240, v[196:199] offset:32
  ds_write_b128 v240, v[200:203] offset:48
  ds_write_b128 v240, v[204:207] offset:64
  ds_write_b128 v240, v[208:211] offset:80
  ds_write_b128 v240, v[212:215] offset:96
  ds_write_b128 v240, v[216:219] offset:112
  s_mov_b64 exec, -1
  s_waitcnt lgkmcnt(0)
  s_barrier
  ds_read_b64 v[60:61], v241 offset:0
  ds_read_b64 v[62:63], v241 offset:2048
  ds_read_b64 v[64:65], v241 offset:4096
  ds_read_b64 v[66:67], v241 offset:6144
  ds_read_b64 v[68:69], v241 offset:8192
  ds_read_b64 v[70:71], v241 offset:10240
  ds_read_b64 v[72:73], v241 offset:12288
  ds_read_b64 v[74:75], v241 offset:14336
  s_waitcnt lgkmcnt(0)
  v_add_f32 v60, v60, v68
  v_add_f32 v62, v62, v70
  v_add_f32 v64, v64, v72
  v_add_f32 v66, v66, v74
  v_add_f32 v60, v60, v62
  v_add_f32 v64, v64, v66
  v_add_f32 v60, v60, v64
  v_add_f32 v220, v60, v76
  v_add_f32 v61, v61, v69
  v_add_f32 v63, v63, v71
  v_add_f32 v65, v65, v73
  v_add_f32 v67, v67, v75
  v_add_f32 v61, v61, v63
  v_add_f32 v65, v65, v67
  v_add_f32 v61, v61, v65
  v_add_f32 v222, v61, v77
  buffer_store_dwordx4 v[220:223], v242, s[12:15], s80 offen sc1
  s_endpgm
L_final:
  s_waitcnt vmcnt(0)
  s_lshl_b32 s78, s2, 12
  s_add_u32 s78, s78, 2097152
  s_lshl_b32 s80, s68, 10
  s_bfe_u32 s77, s2, 0x40001
  s_lshl_b32 s77, s77, 6
  s_add_u32 s80, s80, s77
  s_and_b32 s77, s2, 1
  s_lshl_b32 s77, s77, 3
  s_add_u32 s80, s80, s77
  v_and_b32 v238, 1, v1
  v_lshlrev_b32 v238, 5, v238
  v_bfe_u32 v7, v1, 1, 2
  v_lshl_add_u32 v238, v7, 1, v238
  s_barrier
  s_barrier
  s_mov_b32 s96, 400000
L_fin_chk:
  buffer_load_dwordx4 v[156:159], v3, s[12:15], s78 offen offset:0 sc1
  buffer_load_dwordx4 v[160:163], v3, s[12:15], s78 offen offset:1024 sc1
  buffer_load_dwordx4 v[164:167], v3, s[12:15], s78 offen offset:2048 sc1
  buffer_load_dwordx4 v[168:171], v3, s[12:15], s78 offen offset:3072 sc1
  s_waitcnt vmcnt(0)
  s_mov_b64 exec, -1
  v_xor_b32 v8, s66, v157
  v_xor_b32 v9, s67, v159
  v_or_b32 v7, v8, v9
  v_xor_b32 v8, s66, v161
  v_xor_b32 v9, s67, v163
  v_or3_b32 v7, v7, v8, v9
  v_xor_b32 v8, s66, v165
  v_xor_b32 v9, s67, v167
  v_or3_b32 v7, v7, v8, v9
  v_xor_b32 v8, s66, v169
  v_xor_b32 v9, s67, v171
  v_or3_b32 v7, v7, v8, v9
  v_cmp_ne_u32 vcc, 0, v7
  s_cbranch_vccz L_fin_ok
  s_bcnt1_i32_b64 s77, vcc
  s_mov_b64 exec, vcc
  s_cmp_le_u32 s77, 32
  s_cbranch_scc1 L_fin_ns
  s_sleep 8
L_fin_ns:
  s_sub_u32 s96, s96, 1
  s_cmp_lg_u32 s96, 0
  s_cbranch_scc1 L_fin_chk
  s_mov_b64 exec, -1
L_fin_ok:
  v_add_f32 v20, v156, v160
  v_add_f32 v22, v164, v168
  v_add_f32 v20, v20, v22
  v_add_f32 v21, v158, v162
  v_add_f32 v23, v166, v170
  v_add_f32 v21, v21, v23
  s_nop 1
  v_add_f32_dpp v20, v20, v20 row_ror:8 row_mask:0xf bank_mask:0xf
  v_add_f32_dpp v21, v21, v21 row_ror:8 row_mask:0xf bank_mask:0xf
  v_mov_b32 v24, v20
  v_mov_b32 v25, v21
  s_nop 1
  v_permlane32_swap_b32 v20, v24
  v_permlane32_swap_b32 v21, v25
  v_add_f32 v20, v20, v24
  v_add_f32 v21, v21, v25
  v_mov_b32 v24, v20
  v_mov_b32 v25, v21
  s_nop 1
  v_permlane16_swap_b32 v20, v24
  v_permlane16_swap_b32 v21, v25
  v_add_f32 v20, v20, v24
  v_add_f32 v21, v21, v25
  s_nop 1
  v_mov_b32_dpp v24, v20 quad_perm:[2,3,2,3] row_mask:0xf bank_mask:0xf
  v_mov_b32_dpp v25, v21 quad_perm:[2,3,2,3] row_mask:0xf bank_mask:0xf
  v_cvt_pk_bf16_f32 v20, v20, v24
  v_cvt_pk_bf16_f32 v21, v21, v25
  s_mov_b64 exec, 0x33
  buffer_store_dword v20, v238, s[32:35], s80 offen offset:0
  buffer_store_dword v21, v238, s[32:35], s80 offen offset:16
  s_cmp_lg_u32 s2, 0
  s_cbranch_scc1 L_noepoch
  s_mov_b64 exec, 1
  v_mov_b32 v16, s66
  v_mov_b32 v17, s67
  buffer_store_dwordx2 v[16:17], v238, s[12:15], 0 offen offset:0 sc1
L_noepoch:
  s_mov_b64 exec, -1
L_end2:
L_end:
  s_endpgm
L_x_issue:
  v_lshrrev_b32 v8, 4, v1
  v_bfe_u32 v7, v1, 3, 1
  v_and_b32 v9, 7, v1
  v_and_b32 v10, 0x28, v1
  v_cmp_eq_u32 vcc, 0x28, v10
  s_cmp_eq_u32 s3, 5
  s_cselect_b64 s[88:89], vcc, 0
  v_lshlrev_b32 v239, 14, v9
  v_lshl_add_u32 v239, v7, 6, v239
  v_lshl_add_u32 v239, v8, 4, v239
  v_add_u32 v10, -32, v239
  v_cndmask_b32 v239, v239, v10, s[88:89]
  v_lshlrev_b32 v240, 2, v9
  v_add_u32 v240, 82688, v240
  ds_read_b32 v244, v240
  s_sub_u32 s77, s3, 4
  s_cmp_gt_u32 s77, 1
  s_cbranch_scc1 L_xi_done
  s_mul_i32 s78, s71, 224
  s_and_b32 s77, s3, 1
  s_lshl_b32 s77, s77, 7
  s_add_u32 s78, s78, s77
  s_add_u32 s78, s78, 262144
  s_add_u32 s79, s78, 7168
  buffer_load_dwordx4 v[220:223], v239, s[12:15], s78 offen sc1
  buffer_load_dwordx4 v[224:227], v239, s[12:15], s79 offen sc1
L_xi_done:
  s_waitcnt lgkmcnt(0)
  s_branch L_loop_b
L_x_process:
  s_sub_u32 s77, s3, 4
  s_cmp_gt_u32 s77, 1
  s_cbranch_scc1 L_xp_done
  s_mov_b32 s96, 200000
L_gu_chk:
  v_xor_b32 v8, s66, v221
  v_xor_b32 v9, s67, v223
  v_or_b32 v7, v8, v9
  v_xor_b32 v8, s66, v225
  v_xor_b32 v9, s67, v227
  v_or3_b32 v7, v7, v8, v9
  v_cmp_ne_u32 vcc, 0, v7
  s_cbranch_vccz L_gu_ok
  s_sleep 8
  s_mul_i32 s78, s71, 224
  s_and_b32 s77, s3, 1
  s_lshl_b32 s77, s77, 7
  s_add_u32 s78, s78, s77
  s_add_u32 s78, s78, 262144
  s_add_u32 s79, s78, 7168
  buffer_load_dwordx4 v[220:223], v239, s[12:15], s78 offen sc1
  buffer_load_dwordx4 v[224:227], v239, s[12:15], s79 offen sc1
  s_waitcnt vmcnt(0)
  s_sub_u32 s96, s96, 1
  s_cmp_lg_u32 s96, 0
  s_cbranch_scc1 L_gu_chk
L_gu_ok:
  s_and_b32 s77, s3, 1
  s_lshl_b32 s77, s77, 12
  v_add_u32 v10, s77, v3
  ds_read_b128 v[60:63], v10 offset:16384
  ds_read_b128 v[64:67], v10 offset:17408
  ds_read_b128 v[68:71], v10 offset:18432
  ds_read_b128 v[72:75], v10 offset:19456
  v_sub_f32 v10, 1.0, v244
  v_cndmask_b32 v10, v10, 0, s[88:89]
  v_lshlrev_b32 v20, 16, v220
  v_and_b32 v21, 0xffff0000, v220
  v_mul_f32 v20, 0xbfb8aa3b, v20
  v_exp_f32 v20, v20
  s_nop 0
  v_add_f32 v20, 1.0, v20
  v_rcp_f32 v20, v20
  v_mul_f32 v21, 0xbfb8aa3b, v21
  v_exp_f32 v21, v21
  s_nop 0
  v_add_f32 v21, 1.0, v21
  v_rcp_f32 v21, v21
  v_lshlrev_b32 v7, 16, v224
  v_and_b32 v8, 0xffff0000, v224
  v_mul_f32 v7, v7, v10
  v_mul_f32 v8, v8, v10
  v_mul_f32 v20, v20, v7
  v_mul_f32 v21, v21, v8
  v_cvt_pk_bf16_f32 v16, v20, v21
  v_lshlrev_b32 v22, 16, v222
  v_and_b32 v23, 0xffff0000, v222
  v_mul_f32 v22, 0xbfb8aa3b, v22
  v_exp_f32 v22, v22
  s_nop 0
  v_add_f32 v22, 1.0, v22
  v_rcp_f32 v22, v22
  v_mul_f32 v23, 0xbfb8aa3b, v23
  v_exp_f32 v23, v23
  s_nop 0
  v_add_f32 v23, 1.0, v23
  v_rcp_f32 v23, v23
  v_lshlrev_b32 v7, 16, v226
  v_and_b32 v8, 0xffff0000, v226
  v_mul_f32 v7, v7, v10
  v_mul_f32 v8, v8, v10
  v_mul_f32 v22, v22, v7
  v_mul_f32 v23, v23, v8
  v_cvt_pk_bf16_f32 v17, v22, v23
  v_lshrrev_b32 v7, 5, v1
  v_bfe_u32 v8, v1, 4, 1
  v_and_b32 v9, 7, v1
  v_lshlrev_b32 v7, 11, v7
  v_lshl_add_u32 v7, v8, 7, v7
  v_lshl_add_u32 v7, v9, 8, v7
  s_and_b32 s77, s3, 1
  s_lshl_b32 s77, s77, 12
  s_add_u32 s77, s77, 57344
  v_add_u32 v9, s77, v7
  s_waitcnt lgkmcnt(0)
  v_perm_b32 v220, v64, v60, s94
  v_perm_b32 v221, v72, v68, s94
  v_perm_b32 v222, v64, v60, s95
  v_perm_b32 v223, v72, v68, s95
  v_perm_b32 v224, v65, v61, s94
  v_perm_b32 v225, v73, v69, s94
  v_perm_b32 v226, v65, v61, s95
  v_perm_b32 v227, v73, v69, s95
  s_nop 1
  v_mfma_f32_16x16x16_bf16 v[76:79], v[220:221], v[16:17], 0
  v_mfma_f32_16x16x16_bf16 v[80:83], v[222:223], v[16:17], 0
  v_mfma_f32_16x16x16_bf16 v[84:87], v[224:225], v[16:17], 0
  v_mfma_f32_16x16x16_bf16 v[88:91], v[226:227], v[16:17], 0
  s_nop 7
  s_mov_b64 exec, s[90:91]
  ds_write_b128 v9, v[76:79] offset:0
  ds_write_b128 v9, v[80:83] offset:16
  ds_write_b128 v9, v[84:87] offset:32
  ds_write_b128 v9, v[88:91] offset:48
  s_mov_b64 exec, -1
  v_perm_b32 v220, v66, v62, s94
  v_perm_b32 v221, v74, v70, s94
  v_perm_b32 v222, v66, v62, s95
  v_perm_b32 v223, v74, v70, s95
  v_perm_b32 v224, v67, v63, s94
  v_perm_b32 v225, v75, v71, s94
  v_perm_b32 v226, v67, v63, s95
  v_perm_b32 v227, v75, v71, s95
  s_nop 1
  v_mfma_f32_16x16x16_bf16 v[76:79], v[220:221], v[16:17], 0
  v_mfma_f32_16x16x16_bf16 v[80:83], v[222:223], v[16:17], 0
  v_mfma_f32_16x16x16_bf16 v[84:87], v[224:225], v[16:17], 0
  v_mfma_f32_16x16x16_bf16 v[88:91], v[226:227], v[16:17], 0
  s_nop 7
  s_mov_b64 exec, s[90:91]
  ds_write_b128 v9, v[76:79] offset:64
  ds_write_b128 v9, v[80:83] offset:80
  ds_write_b128 v9, v[84:87] offset:96
  ds_write_b128 v9, v[88:91] offset:112
  s_mov_b64 exec, -1
  s_waitcnt lgkmcnt(0)
L_xp_done:
  s_branch L_loop_c
L_code_end:
  s_endpgm
.section .rodata,"a"
.p2align 6
.amdhsa_kernel gated_mix__gqa_block_cached__glu_gated_glu__decode_kernel
  .amdhsa_next_free_vgpr 246
  .amdhsa_next_free_sgpr 102
  .amdhsa_accum_offset 248
  .amdhsa_group_segment_fixed_size 0
  .amdhsa_kernarg_size 104
  .amdhsa_user_sgpr_count 2
  .amdhsa_user_sgpr_kernarg_segment_ptr 1
  .amdhsa_system_sgpr_workgroup_id_x 1
.end_amdhsa_kernel
```
